```python
import torch

def _softmax(x, axis=-1):
    return torch.softmax(x, dim=axis)
def _gelu(x):
    return torch.nn.functional.gelu(x, approximate="tanh")
def _silu(x):
    return torch.nn.functional.silu(x)
def _sigmoid(x):
    return torch.sigmoid(x)
def _layernorm(x, axis=-1, eps=1e-5):
    m = x.mean(dim=axis, keepdim=True)
    v = x.var(dim=axis, keepdim=True, unbiased=False)
    return (x - m) / torch.sqrt(v + eps)
def _scatter_add(tgt, idx, src, axis=0):
    return tgt.clone().index_add_(axis, idx, src)
def _segment_sum(src, seg, n):
    out = torch.zeros((n,) + src.shape[1:], dtype=src.dtype)
    return out.index_add_(0, seg, src)
def _pad(x, pw):
    flat = tuple(v for pair in reversed(pw) for v in pair)
    return torch.nn.functional.pad(x, flat)

kernel_name = 'sequential_preLN__sliding_block__dense_activation_silu__prompt'

def setup_inputs():

    _w = (lambda a: (lambda t: t.to(torch.bfloat16) if t.is_floating_point() else t)(torch.as_tensor(a)))
    def _A_setup():
        B, S, D = 1, 2048, 512
        return {
            "x": _w((lambda *s: torch.randn(*s, dtype=torch.bfloat16) * 0.05)(B, S, D)),
            "wqkv": _w((lambda *s: torch.randn(*s, dtype=torch.bfloat16) * 0.05)(D, 3 * D)),
            "wo": _w((lambda *s: torch.randn(*s, dtype=torch.bfloat16) * 0.05)(D, D)),
        }
    _A_in = _A_setup()

    def _B_setup():
        B, S, D, F = 1, 2048, 512, 1792
        return {
            "x": _w((lambda *s: torch.randn(*s, dtype=torch.bfloat16) * 0.05)(B, S, D)),
            "w1": _w((lambda *s: torch.randn(*s, dtype=torch.bfloat16) * 0.8)(D, F) * (D ** -0.5)),
            "w2": _w((lambda *s: torch.randn(*s, dtype=torch.bfloat16) * 0.8)(F, D) * (F ** -0.5)),
        }
    _B_in = _B_setup()

    return {
        "A_x": _A_in["x"],
        "A_wqkv": _A_in["wqkv"],
        "A_wo": _A_in["wo"],
        "B_x": _B_in["x"],
        "B_w1": _B_in["w1"],
        "B_w2": _B_in["w2"],
    }

def reference(A_x, A_wqkv, A_wo, B_x, B_w1, B_w2):
    def _A_ref(x, wqkv, wo):
        B, S, D = x.shape
        H = 32; Dh = D // H; W = 256
        qkv = (lambda x, *d: x.permute(*d))((x @ wqkv).reshape(B, S, 3, H, Dh), 2, 0, 3, 1, 4)
        q, k, v = qkv[0], qkv[1], qkv[2]
        scores = torch.einsum("bhqd,bhkd->bhqk", q, k) * (Dh ** -0.5)
        idx = torch.arange(S)
        mask = (idx[:, None] - idx[None, :] >= 0) & (idx[:, None] - idx[None, :] < W)
        scores = torch.where(mask[None, None], scores, -1e9)
        p = _softmax(scores, axis=-1)
        o = torch.einsum("bhqk,bhkd->bhqd", p, v)
        return (lambda x, *d: x.permute(*d))(o, 0, 2, 1, 3).reshape(B, S, D) @ wo

    def _B_ref(x, w1, w2):
        h = torch.einsum("bsd,df->bsf", x, w1)
        h = _silu(h)
        out = torch.einsum("bsf,fd->bsd", h, w2)
        return out

    x = A_x
    h = x + _A_ref(_layernorm(x, axis=-1), A_wqkv, A_wo)
    h2 = h + _B_ref(_layernorm(h, axis=-1), B_w1, B_w2)
    return h2
```

```asm
; @launch grid=(256,1,1) block=(256,1,1) lds=163840
.amdgcn_target "amdgcn-amd-amdhsa--gfx950"
.text
.globl sequential_preLN__sliding_block__dense_activation_silu__prompt_kernel
.p2align 8
.type sequential_preLN__sliding_block__dense_activation_silu__prompt_kernel,@function
sequential_preLN__sliding_block__dense_activation_silu__prompt_kernel:
    s_cmp_ge_u32 s2, 256
    s_cbranch_scc1 L_end
    s_load_dwordx16 s[40:55], s[0:1], 0x0
    s_load_dwordx2 s[56:57], s[0:1], 0x40
    s_getpc_b64 s[62:63]
L_pc:
    v_lshrrev_b32 v4, 6, v0
    v_and_b32 v1, 63, v0
    v_readfirstlane_b32 s66, v4
    v_lshlrev_b32 v2, 4, v1
    s_lshr_b32 s69, s2, 3
    s_and_b32 s70, s69, 3
    s_mul_i32 s70, s70, 9216
    v_mul_u32_u24 v4, 2304, v4
    v_lshl_add_u32 v5, v1, 7, s70
    v_add_u32 v5, v4, v5
    v_min_u32 v5, L_code_end-L_pc-4, v5
    s_mov_b64 exec, 0x3ffff
    global_load_dword v3, v5, s[62:63]
    s_mov_b64 exec, -1
    s_and_b32 s65, s69, 7
    s_and_b32 s64, s2, 7
    s_lshl_b32 s64, s64, 2
    s_lshr_b32 s70, s2, 6
    s_add_u32 s64, s64, s70
    s_lshl_b32 s77, s64, 16
    s_lshl_b32 s70, s66, 14
    s_add_u32 s77, s77, s70
    s_mul_i32 s78, s66, 16640
    s_mov_b32 s7, 0x20000
    s_mov_b32 s6, 0x200000
    s_waitcnt lgkmcnt(0)
    s_and_b32 s5, s41, 0xffff
    s_mov_b32 s4, s40
    s_lshl_b32 s79, s65, 1
    s_xor_b32 s71, s79, 0
    s_mul_i32 s80, s71, 1040
    s_add_u32 m0, s78, s80
    s_lshl_b32 s71, s71, 10
    s_add_u32 s69, s77, s71
    buffer_load_dwordx4 v2, s[4:7], s69 offen lds
    s_mov_b32 s8, s42
    s_and_b32 s9, s43, 0xffff
    s_mov_b32 s10, 0x180000
    s_mov_b32 s11, 0x20000
    s_xor_b32 s71, s79, 1
    s_mul_i32 s80, s71, 1040
    s_add_u32 m0, s78, s80
    s_lshl_b32 s71, s71, 10
    s_add_u32 s69, s77, s71
    buffer_load_dwordx4 v2, s[4:7], s69 offen lds
    s_and_b32 s67, s66, 1
    s_lshr_b32 s68, s66, 1
    v_lshrrev_b32 v8, 3, v1
    v_lshrrev_b32 v4, 2, v1
    s_xor_b32 s71, s79, 2
    s_mul_i32 s80, s71, 1040
    s_add_u32 m0, s78, s80
    s_lshl_b32 s71, s71, 10
    s_add_u32 s69, s77, s71
    buffer_load_dwordx4 v2, s[4:7], s69 offen lds
    v_and_b32 v4, 4, v4
    v_xor_b32 v4, v4, v1
    v_and_b32 v4, 7, v4
    v_lshlrev_b32 v9, 4, v4
    s_xor_b32 s71, s79, 3
    s_mul_i32 s80, s71, 1040
    s_add_u32 m0, s78, s80
    s_lshl_b32 s71, s71, 10
    s_add_u32 s69, s77, s71
    buffer_load_dwordx4 v2, s[4:7], s69 offen lds
    v_mul_u32_u24 v4, 3072, v8
    v_add_u32 v12, v4, v9
    v_add_u32 v13, 23552, v12
    v_add_u32 v14, 47104, v12
    s_xor_b32 s71, s79, 4
    s_mul_i32 s80, s71, 1040
    s_add_u32 m0, s78, s80
    s_lshl_b32 s71, s71, 10
    s_add_u32 s69, s77, s71
    buffer_load_dwordx4 v2, s[4:7], s69 offen lds
    v_add_u32 v15, 70656, v12
    s_mul_i32 s73, s67, 98304
    s_lshl_b32 s70, s68, 10
    s_add_u32 s73, s73, s70
    s_xor_b32 s71, s79, 5
    s_mul_i32 s80, s71, 1040
    s_add_u32 m0, s78, s80
    s_lshl_b32 s71, s71, 10
    s_add_u32 s69, s77, s71
    buffer_load_dwordx4 v2, s[4:7], s69 offen lds
    s_lshl_b32 s70, s65, 7
    s_add_u32 s73, s73, s70
    s_add_u32 s73, s73, 1024
    s_lshl_b32 s74, s66, 12
    s_xor_b32 s71, s79, 6
    s_mul_i32 s80, s71, 1040
    s_add_u32 m0, s78, s80
    s_lshl_b32 s71, s71, 10
    s_add_u32 s69, s77, s71
    buffer_load_dwordx4 v2, s[4:7], s69 offen lds
    s_mul_i32 s75, s67, 98304
    s_add_u32 s75, s75, s70
    s_and_b32 s83, s2, 7
    s_lshr_b32 s85, s2, 6
    s_xor_b32 s71, s79, 7
    s_mul_i32 s80, s71, 1040
    s_add_u32 m0, s78, s80
    s_lshl_b32 s71, s71, 10
    s_add_u32 s69, s77, s71
    buffer_load_dwordx4 v2, s[4:7], s69 offen lds
    s_mul_i32 s70, s85, 0
    s_xor_b32 s83, s83, s70
    s_and_b32 s83, s83, 7
    s_xor_b32 s76, s83, s68
    s_xor_b32 s71, s79, 8
    s_mul_i32 s80, s71, 1040
    s_add_u32 m0, s78, s80
    s_lshl_b32 s71, s71, 10
    s_add_u32 s69, s77, s71
    buffer_load_dwordx4 v2, s[4:7], s69 offen lds
    s_mov_b32 s12, s44
    s_and_b32 s13, s45, 0xffff
    s_mov_b32 s14, 0x80000
    s_mov_b32 s15, 0x20000
    s_xor_b32 s71, s79, 9
    s_mul_i32 s80, s71, 1040
    s_add_u32 m0, s78, s80
    s_lshl_b32 s71, s71, 10
    s_add_u32 s69, s77, s71
    buffer_load_dwordx4 v2, s[4:7], s69 offen lds
    s_mov_b32 s16, s48
    s_and_b32 s17, s49, 0xffff
    s_mov_b32 s18, 0x1c0000
    s_mov_b32 s19, 0x20000
    s_xor_b32 s71, s79, 10
    s_mul_i32 s80, s71, 1040
    s_add_u32 m0, s78, s80
    s_lshl_b32 s71, s71, 10
    s_add_u32 s69, s77, s71
    buffer_load_dwordx4 v2, s[4:7], s69 offen lds
    s_mov_b32 s20, s50
    s_and_b32 s21, s51, 0xffff
    s_mov_b32 s22, 0x1c0000
    s_mov_b32 s23, 0x20000
    s_xor_b32 s71, s79, 11
    s_mul_i32 s80, s71, 1040
    s_add_u32 m0, s78, s80
    s_lshl_b32 s71, s71, 10
    s_add_u32 s69, s77, s71
    buffer_load_dwordx4 v2, s[4:7], s69 offen lds
    s_mov_b32 s32, s54
    s_and_b32 s33, s55, 0xffff
    s_mov_b32 s34, 0x100
    s_mov_b32 s35, 0x20000
    s_xor_b32 s71, s79, 12
    s_mul_i32 s80, s71, 1040
    s_add_u32 m0, s78, s80
    s_lshl_b32 s71, s71, 10
    s_add_u32 s69, s77, s71
    buffer_load_dwordx4 v2, s[4:7], s69 offen lds
    s_mov_b32 s24, s52
    s_and_b32 s25, s53, 0xffff
    s_mov_b32 s26, 0x200000
    s_mov_b32 s27, 0x20000
    s_xor_b32 s71, s79, 13
    s_mul_i32 s80, s71, 1040
    s_add_u32 m0, s78, s80
    s_lshl_b32 s71, s71, 10
    s_add_u32 s69, s77, s71
    buffer_load_dwordx4 v2, s[4:7], s69 offen lds
    s_mov_b32 s28, s56
    s_and_b32 s29, s57, 0xffff
    s_mov_b32 s30, 0x2000000
    s_mov_b32 s31, 0x20000
    s_xor_b32 s71, s79, 14
    s_mul_i32 s80, s71, 1040
    s_add_u32 m0, s78, s80
    s_lshl_b32 s71, s71, 10
    s_add_u32 s69, s77, s71
    buffer_load_dwordx4 v2, s[4:7], s69 offen lds
    s_lshl_b32 s70, s65, 14
    s_add_u32 s36, s56, s70
    s_add_u32 s36, s56, s70
    s_addc_u32 s37, s57, 0
    s_and_b32 s37, s37, 0xffff
    s_xor_b32 s71, s79, 15
    s_mul_i32 s80, s71, 1040
    s_add_u32 m0, s78, s80
    s_lshl_b32 s71, s71, 10
    s_add_u32 s69, s77, s71
    buffer_load_dwordx4 v2, s[4:7], s69 offen lds
    s_mov_b32 s38, 0x400000
    s_mov_b32 s39, 0x20000
    s_mov_b32 s72, 0x3f803f80
    v_cmp_eq_u32 vcc, 0, v1
    v_mov_b32 v4, 0x7ffffff0
    v_lshlrev_b32 v5, 7, v1
    v_cndmask_b32 v10, v4, 0, vcc
    s_lshr_b32 s0, s2, 3
    s_lshl_b32 s0, s0, 2
    s_add_u32 s0, s0, s66
    v_lshl_add_u32 v5, v8, 10, v9
    s_lshr_b32 s69, s8, 7
    s_sub_u32 s69, 3, s69
    s_and_b32 s69, s69, 7
    s_lshl_b32 s69, s69, 7
    s_mul_i32 s41, s0, 12288
    s_add_u32 s41, s41, s69
    s_mov_b32 m0, 156928
    s_mov_b32 exec_hi, 0xffff
    buffer_load_dwordx4 v5, s[8:11], s41 offen lds
    s_mov_b32 exec_hi, -1
    s_add_u32 s41, s41, 6144
    s_mov_b32 m0, 156928
    s_mov_b32 exec_hi, 0xffff
    buffer_load_dwordx4 v5, s[8:11], s41 offen lds
    s_mov_b32 exec_hi, -1
    s_xor_b32 s84, s83, 0
    s_mul_i32 s84, s84, 196608
    s_add_u32 s84, s84, s73
    s_add_u32 m0, s74, 0x1c500
    s_add_u32 s80, s84, 0x0
    buffer_load_dwordx4 v12, s[8:11], s80 offen lds
    buffer_load_dwordx4 v13, s[8:11], s80 offen offset:1024 lds
    buffer_load_dwordx4 v14, s[8:11], s80 offen offset:2048 lds
    buffer_load_dwordx4 v15, s[8:11], s80 offen offset:3072 lds
    s_or_b32 s69, s2, s66
    s_cmp_lg_u32 s69, 0
    s_cbranch_scc1 L_nonce_1
    s_memrealtime s[58:59]
    s_waitcnt lgkmcnt(0)
    s_or_b32 s58, s58, 1
    v_mov_b32 v16, s58
    v_mov_b32 v17, s59
    buffer_store_dwordx2 v[16:17], v10, s[32:35], 0 offen sc1
L_nonce_1:
    v_and_b32 v11, 31, v1
    v_lshrrev_b32 v18, 5, v1
    v_bfe_u32 v4, v1, 2, 2
    v_lshrrev_b32 v24, 1, v4
    v_lshlrev_b32 v4, 7, v4
    v_bfe_u32 v5, v1, 4, 1
    v_lshl_add_u32 v4, v5, 5, v4
    v_and_b32 v5, 3, v1
    v_lshl_add_u32 v19, v5, 3, v4
    s_xor_b32 s43, s67, s68
    s_lshl_b32 s69, s67, 5
    v_add_u32 v4, s69, v11
    v_mul_u32_u24 v4, 1040, v4
    v_mov_b32 v58, v4
    v_lshl_add_u32 v4, v18, 4, v4
    s_lshl_b32 s69, s43, 5
    v_add_u32 v56, s69, v4
    s_sub_u32 s69, 32, s69
    v_add_u32 v57, s69, v4
    v_xor_b32 v4, s68, v24
    v_lshl_add_u32 v5, v4, 6, v19
    v_mul_u32_u24 v4, 1024, v18
    v_add_u32 v5, v5, v4
    s_lshl_b32 s69, s43, 11
    s_sub_u32 s70, 2048, s69
    s_add_u32 s77, s69, 66560
    v_add_u32 v59, s77, v5
    s_add_u32 s77, s70, 66560
    v_add_u32 v62, s77, v5
    s_add_u32 s77, s69, 115968
    v_add_u32 v60, s77, v5
    s_add_u32 s77, s70, 115968
    v_add_u32 v63, s77, v5
    s_add_u32 s77, s69, 0
    v_add_u32 v61, s77, v5
    s_add_u32 s77, s70, 0
    v_add_u32 v64, s77, v5
    s_lshl_b32 s69, s67, 8
    s_add_u32 s69, s69, 148736
    v_lshl_add_u32 v66, v11, 3, s69
    s_lshl_b32 s70, s68, 9
    v_lshl_add_u32 v65, v18, 2, v66
    v_add_u32 v65, s70, v65
    s_lshl_b32 s69, s68, 7
    s_add_u32 s69, s69, 149760
    v_lshl_add_u32 v4, v11, 2, s69
    s_lshl_b32 s70, s67, 10
    s_add_u32 s70, s70, s69
    v_and_b32 v67, 48, v1
    v_and_b32 v6, 1, v1
    v_lshl_add_u32 v67, v6, 6, v67
    v_add_u32 v67, s70, v67
    v_bfe_u32 v6, v1, 4, 1
    v_and_b32 v7, 15, v1
    v_cmp_eq_u32 vcc, v6, v7
    v_mov_b32 v6, s72
    s_mov_b32 s42, 0x00030003
    v_cndmask_b32 v6, 0, v6, vcc
    v_accvgpr_write_b32 a152, v6
    v_accvgpr_write_b32 a153, v6
    v_accvgpr_write_b32 a154, v6
    v_accvgpr_write_b32 a155, v6
    v_add_u32 v69, 256, v4
    v_lshl_add_u32 v68, v18, 4, s69
    s_lshl_b32 s69, s66, 8
    s_add_u32 s69, s69, 151808
    v_lshl_add_u32 v70, v1, 2, s69
    v_lshl_add_u32 v71, v18, 4, s69
    v_mov_b32 v208, 0
    v_mov_b32 v209, 0
    v_min_u32 v6, 39, v1
    v_lshrrev_b32 v26, 1, v6
    v_mul_u32_u24 v26, 4160, v26
    v_and_b32 v7, 1, v6
    v_mul_u32_u24 v7, 1040, v7
    v_add_u32 v26, v26, v7
    v_lshrrev_b32 v6, 2, v6
    s_lshl_b32 s69, s64, 1
    v_add_u32 v6, s69, v6
    v_cmp_le_u32 s[60:61], 8, v6
    v_mov_b32 v7, s72
    s_mul_i32 s69, s67, 8320
    v_cndmask_b32 v44, 0, v7, s[60:61]
    v_mov_b32 v45, v44
    v_mov_b32 v46, v44
    v_mov_b32 v47, v44
    s_mul_i32 s70, s68, 4160
    s_add_u32 s79, s69, s70
    s_add_u32 s69, s79, 66560
    v_add_u32 v220, s69, v2
    s_lshl_b32 s43, s64, 17
    s_lshl_b32 s69, s67, 13
    s_add_u32 s43, s43, s69
    s_lshl_b32 s69, s68, 12
    s_add_u32 s43, s43, s69
    s_lshl_b32 s1, s64, 1
    s_add_u32 s1, s1, s67
    s_and_b32 s6, s65, 1
    s_lshl_b32 s70, s67, 13
    s_lshl_b32 s40, s64, 17
    s_add_u32 s40, s40, s70
    s_lshl_b32 s70, s65, 14
    s_add_u32 s3, s43, s70
    s_add_u32 s4, s3, 0x400000
    s_lshl_b32 s5, s65, 2
    s_add_u32 s5, s5, s66
    s_lshl_b32 s5, s5, 9
    s_add_u32 s5, s5, 0x1030000
    s_lshl_b32 s77, s65, 5
    s_add_u32 s77, s77, s64
    s_lshl_b32 s77, s77, 2
    s_add_u32 s77, s77, s66
    s_lshl_b32 s77, s77, 3
    s_add_u32 s77, s77, 0x1000000
    s_mul_i32 s44, s66, 458752
    s_lshl_b32 s70, s65, 7
    s_add_u32 s44, s44, s70
    s_lshl_b32 s45, s66, 14
    s_add_u32 s71, s45, 83200
    v_xor_b32 v4, s68, v24
    v_lshl_add_u32 v27, v4, 6, v19
    v_mul_u32_u24 v4, 512, v18
    v_add3_u32 v27, v27, v4, s71
    v_xor_b32 v48, 64, v27
    v_bfe_u32 v4, v1, 1, 2
    s_sub_u32 s69, s64, 4
    v_add_u32 v4, s69, v4
    v_mov_b32 v5, s64
    v_cmp_gt_i32 vcc, 0, v4
    v_and_b32 v6, 1, v1
    s_lshl_b32 s48, s65, 10
    v_cndmask_b32 v4, v4, v5, vcc
    v_lshlrev_b32 v6, 4, v6
    v_lshl_add_u32 v49, v4, 5, v6
    s_add_u32 s48, s48, 0x1000000
    s_mul_i32 s49, s66, 4160
    s_lshr_b32 s71, s65, 2
    s_and_b32 s69, s65, 3
    s_mul_i32 s46, s64, 256
    s_mul_i32 s70, s71, 8192
    s_add_u32 s46, s46, s70
    s_mul_i32 s70, s69, 64
    s_add_u32 s46, s46, s70
    s_mul_i32 s70, s66, 16
    s_add_u32 s46, s46, s70
    s_add_u32 s46, s46, 0x102a000
    s_getreg_b32 s81, hwreg(HW_REG_XCC_ID, 0, 4)
    v_lshrrev_b32 v4, 1, v11
    v_and_b32 v4, 7, v4
    v_xor_b32 v4, v4, v18
    s_add_u32 s71, s45, 0
    v_lshl_add_u32 v5, v11, 7, s71
    v_xor_b32 v6, 0, v4
    v_lshl_add_u32 v50, v6, 4, v5
    v_xor_b32 v6, 2, v4
    v_lshl_add_u32 v51, v6, 4, v5
    v_xor_b32 v6, 4, v4
    v_lshl_add_u32 v52, v6, 4, v5
    v_xor_b32 v6, 6, v4
    v_lshl_add_u32 v53, v6, 4, v5
    s_lshl_b32 s47, s64, 3
    s_add_u32 s47, s47, s65
    s_lshl_b32 s47, s47, 2
    s_add_u32 s47, s47, s66
    s_lshl_b32 s47, s47, 9
    s_add_u32 s47, s47, 0xf40000
    s_lshl_b32 s71, s64, 8
    s_add_u32 s71, s71, 0x102a000
    v_and_b32 v55, 16, v11
    v_mul_u32_u24 v55, 496, v55
    v_lshl_add_u32 v55, v11, 4, v55
    v_add_u32 v55, s71, v55
    s_add_u32 s69, s64, 1
    v_and_b32 v4, 3, v1
    v_add_u32 v4, s69, v4
    v_mov_b32 v5, s64
    v_cmp_lt_u32 vcc, 31, v4
    v_cmp_eq_u32 s[60:61], 0, v18
    s_nop 0
    v_cndmask_b32 v4, v4, v5, vcc
    v_lshl_add_u32 v4, v4, 4, s5
    v_cndmask_b32 v55, v4, v55, s[60:61]
    s_lshl_b32 s50, s64, 14
    s_lshl_b32 s70, s66, 9
    s_add_u32 s50, s50, s70
    s_add_u32 s50, s50, 0xf40000
    s_mul_i32 s51, s64, 256
    s_mul_i32 s70, s67, 128
    s_add_u32 s51, s51, s70
    s_mul_i32 s70, s65, 16
    s_add_u32 s51, s51, s70
    s_mul_i32 s70, s68, 8
    s_add_u32 s51, s51, s70
    s_add_u32 s51, s51, 0x1020000
    s_lshl_b32 s69, s64, 4
    s_add_u32 s5, s69, s5
    s_mul_i32 s69, s65, 448
    s_lshl_b32 s70, s6, 6
    s_add_u32 s69, s69, s70
    s_mul_i32 s52, s66, 114688
    s_add_u32 s52, s52, s69
    s_lshl_b32 s53, s66, 12
    s_mul_i32 s70, s6, 448
    s_sub_u32 s54, s52, s70
    s_lshl_b32 s55, s66, 11
    v_mov_b32 v4, s72
    v_accvgpr_write_b32 a156, v4
    v_accvgpr_write_b32 a157, v4
    v_accvgpr_write_b32 a158, v4
    v_accvgpr_write_b32 a159, v4
    s_waitcnt vmcnt(6)
    s_barrier
    s_xor_b32 s69, s83, 0
    s_lshl_b32 s69, s69, 7
    v_add_u32 v4, s69, v56
    v_add_u32 v5, s69, v57
    s_xor_b32 s84, s83, 1
    s_mul_i32 s84, s84, 196608
    s_add_u32 s84, s84, s73
    s_add_u32 m0, s74, 0x20500
    s_add_u32 s80, s84, 0x0
    buffer_load_dwordx4 v12, s[8:11], s80 offen lds
    ds_read_b128 v[72:75], v4 offset:0
    ds_read_b128 v[76:79], v4 offset:64
    ds_read_b128 a[0:3], v5 offset:0
    ds_read_b128 a[4:7], v5 offset:64
    s_xor_b32 s69, s83, 1
    s_lshl_b32 s69, s69, 7
    v_add_u32 v6, s69, v56
    v_add_u32 v7, s69, v57
    buffer_load_dwordx4 v13, s[8:11], s80 offen offset:1024 lds
    ds_read_b128 v[80:83], v6 offset:0
    ds_read_b128 v[84:87], v6 offset:64
    ds_read_b128 a[8:11], v7 offset:0
    ds_read_b128 a[12:15], v7 offset:64
    s_xor_b32 s69, s83, 2
    s_lshl_b32 s69, s69, 7
    v_add_u32 v4, s69, v56
    v_add_u32 v5, s69, v57
    buffer_load_dwordx4 v14, s[8:11], s80 offen offset:2048 lds
    ds_read_b128 v[88:91], v4 offset:0
    ds_read_b128 v[92:95], v4 offset:64
    ds_read_b128 a[16:19], v5 offset:0
    ds_read_b128 a[20:23], v5 offset:64
    s_waitcnt lgkmcnt(11)
    v_dot2c_f32_bf16 v208, s72, v72
    v_dot2c_f32_bf16 v209, v72, v72
    v_dot2c_f32_bf16 v208, s72, v73
    v_dot2c_f32_bf16 v209, v73, v73
    v_dot2c_f32_bf16 v208, s72, v74
    v_dot2c_f32_bf16 v209, v74, v74
    v_dot2c_f32_bf16 v208, s72, v75
    v_dot2c_f32_bf16 v209, v75, v75
    s_waitcnt lgkmcnt(10)
    v_dot2c_f32_bf16 v208, s72, v76
    v_dot2c_f32_bf16 v209, v76, v76
    v_dot2c_f32_bf16 v208, s72, v77
    v_dot2c_f32_bf16 v209, v77, v77
    v_dot2c_f32_bf16 v208, s72, v78
    v_dot2c_f32_bf16 v209, v78, v78
    v_dot2c_f32_bf16 v208, s72, v79
    v_dot2c_f32_bf16 v209, v79, v79
    s_xor_b32 s69, s83, 3
    s_lshl_b32 s69, s69, 7
    v_add_u32 v6, s69, v56
    v_add_u32 v7, s69, v57
    buffer_load_dwordx4 v15, s[8:11], s80 offen offset:3072 lds
    ds_read_b128 v[96:99], v6 offset:0
    ds_read_b128 v[100:103], v6 offset:64
    ds_read_b128 a[24:27], v7 offset:0
    ds_read_b128 a[28:31], v7 offset:64
    s_waitcnt lgkmcnt(11)
    v_dot2c_f32_bf16 v208, s72, v80
    v_dot2c_f32_bf16 v209, v80, v80
    v_dot2c_f32_bf16 v208, s72, v81
    v_dot2c_f32_bf16 v209, v81, v81
    v_dot2c_f32_bf16 v208, s72, v82
    v_dot2c_f32_bf16 v209, v82, v82
    v_dot2c_f32_bf16 v208, s72, v83
    v_dot2c_f32_bf16 v209, v83, v83
    s_waitcnt lgkmcnt(10)
    v_dot2c_f32_bf16 v208, s72, v84
    v_dot2c_f32_bf16 v209, v84, v84
    v_dot2c_f32_bf16 v208, s72, v85
    v_dot2c_f32_bf16 v209, v85, v85
    v_dot2c_f32_bf16 v208, s72, v86
    v_dot2c_f32_bf16 v209, v86, v86
    v_dot2c_f32_bf16 v208, s72, v87
    v_dot2c_f32_bf16 v209, v87, v87
    s_xor_b32 s69, s83, 4
    s_lshl_b32 s69, s69, 7
    v_add_u32 v4, s69, v56
    v_add_u32 v5, s69, v57
    s_xor_b32 s84, s83, 2
    s_mul_i32 s84, s84, 196608
    s_add_u32 s84, s84, s73
    s_add_u32 m0, s74, 0x10400
    s_add_u32 s80, s84, 0x0
    buffer_load_dwordx4 v12, s[8:11], s80 offen lds
    ds_read_b128 v[104:107], v4 offset:0
    ds_read_b128 v[108:111], v4 offset:64
    ds_read_b128 a[32:35], v5 offset:0
    ds_read_b128 a[36:39], v5 offset:64
    s_waitcnt lgkmcnt(11)
    v_dot2c_f32_bf16 v208, s72, v88
    v_dot2c_f32_bf16 v209, v88, v88
    v_dot2c_f32_bf16 v208, s72, v89
    v_dot2c_f32_bf16 v209, v89, v89
    v_dot2c_f32_bf16 v208, s72, v90
    v_dot2c_f32_bf16 v209, v90, v90
    v_dot2c_f32_bf16 v208, s72, v91
    v_dot2c_f32_bf16 v209, v91, v91
    buffer_load_dwordx4 v13, s[8:11], s80 offen offset:1024 lds
    s_waitcnt lgkmcnt(10)
    v_dot2c_f32_bf16 v208, s72, v92
    v_dot2c_f32_bf16 v209, v92, v92
    v_dot2c_f32_bf16 v208, s72, v93
    v_dot2c_f32_bf16 v209, v93, v93
    v_dot2c_f32_bf16 v208, s72, v94
    v_dot2c_f32_bf16 v209, v94, v94
    v_dot2c_f32_bf16 v208, s72, v95
    v_dot2c_f32_bf16 v209, v95, v95
    s_xor_b32 s69, s83, 5
    s_lshl_b32 s69, s69, 7
    v_add_u32 v6, s69, v56
    v_add_u32 v7, s69, v57
    buffer_load_dwordx4 v14, s[8:11], s80 offen offset:2048 lds
    ds_read_b128 v[112:115], v6 offset:0
    ds_read_b128 v[116:119], v6 offset:64
    ds_read_b128 a[40:43], v7 offset:0
    ds_read_b128 a[44:47], v7 offset:64
    s_waitcnt lgkmcnt(11)
    v_dot2c_f32_bf16 v208, s72, v96
    v_dot2c_f32_bf16 v209, v96, v96
    v_dot2c_f32_bf16 v208, s72, v97
    v_dot2c_f32_bf16 v209, v97, v97
    v_dot2c_f32_bf16 v208, s72, v98
    v_dot2c_f32_bf16 v209, v98, v98
    v_dot2c_f32_bf16 v208, s72, v99
    v_dot2c_f32_bf16 v209, v99, v99
    buffer_load_dwordx4 v15, s[8:11], s80 offen offset:3072 lds
    s_waitcnt lgkmcnt(10)
    v_dot2c_f32_bf16 v208, s72, v100
    v_dot2c_f32_bf16 v209, v100, v100
    v_dot2c_f32_bf16 v208, s72, v101
    v_dot2c_f32_bf16 v209, v101, v101
    v_dot2c_f32_bf16 v208, s72, v102
    v_dot2c_f32_bf16 v209, v102, v102
    v_dot2c_f32_bf16 v208, s72, v103
    v_dot2c_f32_bf16 v209, v103, v103
    s_xor_b32 s69, s83, 6
    s_lshl_b32 s69, s69, 7
    v_add_u32 v4, s69, v56
    v_add_u32 v5, s69, v57
    s_xor_b32 s84, s83, 3
    s_mul_i32 s84, s84, 196608
    s_add_u32 s84, s84, s73
    s_add_u32 m0, s74, 0x14500
    s_add_u32 s80, s84, 0x0
    buffer_load_dwordx4 v12, s[8:11], s80 offen lds
    ds_read_b128 v[120:123], v4 offset:0
    ds_read_b128 v[124:127], v4 offset:64
    ds_read_b128 a[48:51], v5 offset:0
    ds_read_b128 a[52:55], v5 offset:64
    s_waitcnt lgkmcnt(11)
    v_dot2c_f32_bf16 v208, s72, v104
    v_dot2c_f32_bf16 v209, v104, v104
    v_dot2c_f32_bf16 v208, s72, v105
    v_dot2c_f32_bf16 v209, v105, v105
    v_dot2c_f32_bf16 v208, s72, v106
    v_dot2c_f32_bf16 v209, v106, v106
    v_dot2c_f32_bf16 v208, s72, v107
    v_dot2c_f32_bf16 v209, v107, v107
    buffer_load_dwordx4 v13, s[8:11], s80 offen offset:1024 lds
    s_waitcnt lgkmcnt(10)
    v_dot2c_f32_bf16 v208, s72, v108
    v_dot2c_f32_bf16 v209, v108, v108
    v_dot2c_f32_bf16 v208, s72, v109
    v_dot2c_f32_bf16 v209, v109, v109
    v_dot2c_f32_bf16 v208, s72, v110
    v_dot2c_f32_bf16 v209, v110, v110
    v_dot2c_f32_bf16 v208, s72, v111
    v_dot2c_f32_bf16 v209, v111, v111
    s_xor_b32 s69, s83, 7
    s_lshl_b32 s69, s69, 7
    v_add_u32 v6, s69, v56
    v_add_u32 v7, s69, v57
    buffer_load_dwordx4 v14, s[8:11], s80 offen offset:2048 lds
    ds_read_b128 v[128:131], v6 offset:0
    ds_read_b128 v[132:135], v6 offset:64
    ds_read_b128 a[56:59], v7 offset:0
    ds_read_b128 a[60:63], v7 offset:64
    s_waitcnt lgkmcnt(11)
    v_dot2c_f32_bf16 v208, s72, v112
    v_dot2c_f32_bf16 v209, v112, v112
    v_dot2c_f32_bf16 v208, s72, v113
    v_dot2c_f32_bf16 v209, v113, v113
    v_dot2c_f32_bf16 v208, s72, v114
    v_dot2c_f32_bf16 v209, v114, v114
    v_dot2c_f32_bf16 v208, s72, v115
    v_dot2c_f32_bf16 v209, v115, v115
    buffer_load_dwordx4 v15, s[8:11], s80 offen offset:3072 lds
    s_waitcnt lgkmcnt(10)
    v_dot2c_f32_bf16 v208, s72, v116
    v_dot2c_f32_bf16 v209, v116, v116
    v_dot2c_f32_bf16 v208, s72, v117
    v_dot2c_f32_bf16 v209, v117, v117
    v_dot2c_f32_bf16 v208, s72, v118
    v_dot2c_f32_bf16 v209, v118, v118
    v_dot2c_f32_bf16 v208, s72, v119
    v_dot2c_f32_bf16 v209, v119, v119
    s_lshl_b32 s69, s65, 7
    s_lshl_b32 s70, s68, 6
    s_add_u32 s69, s69, s70
    v_lshl_add_u32 v4, v18, 3, s69
    v_add_u32 v4, v4, v58
    s_xor_b32 s84, s83, 4
    s_mul_i32 s84, s84, 196608
    s_add_u32 s84, s84, s73
    s_add_u32 m0, s74, 0x18500
    s_add_u32 s80, s84, 0x0
    buffer_load_dwordx4 v12, s[8:11], s80 offen lds
    ds_read_b64 v[28:29], v4 offset:0
    ds_read_b64 v[30:31], v4 offset:16
    ds_read_b64 v[32:33], v4 offset:32
    ds_read_b64 v[34:35], v4 offset:48
    s_waitcnt lgkmcnt(11)
    v_dot2c_f32_bf16 v208, s72, v120
    v_dot2c_f32_bf16 v209, v120, v120
    v_dot2c_f32_bf16 v208, s72, v121
    v_dot2c_f32_bf16 v209, v121, v121
    v_dot2c_f32_bf16 v208, s72, v122
    v_dot2c_f32_bf16 v209, v122, v122
    v_dot2c_f32_bf16 v208, s72, v123
    v_dot2c_f32_bf16 v209, v123, v123
    buffer_load_dwordx4 v13, s[8:11], s80 offen offset:1024 lds
    s_waitcnt lgkmcnt(10)
    v_dot2c_f32_bf16 v208, s72, v124
    v_dot2c_f32_bf16 v209, v124, v124
    v_dot2c_f32_bf16 v208, s72, v125
    v_dot2c_f32_bf16 v209, v125, v125
    v_dot2c_f32_bf16 v208, s72, v126
    v_dot2c_f32_bf16 v209, v126, v126
    v_dot2c_f32_bf16 v208, s72, v127
    v_dot2c_f32_bf16 v209, v127, v127
    s_waitcnt lgkmcnt(7)
    v_dot2c_f32_bf16 v208, s72, v128
    v_dot2c_f32_bf16 v209, v128, v128
    v_dot2c_f32_bf16 v208, s72, v129
    v_dot2c_f32_bf16 v209, v129, v129
    v_dot2c_f32_bf16 v208, s72, v130
    v_dot2c_f32_bf16 v209, v130, v130
    v_dot2c_f32_bf16 v208, s72, v131
    v_dot2c_f32_bf16 v209, v131, v131
    buffer_load_dwordx4 v14, s[8:11], s80 offen offset:2048 lds
    s_waitcnt lgkmcnt(6)
    v_dot2c_f32_bf16 v208, s72, v132
    v_dot2c_f32_bf16 v209, v132, v132
    v_dot2c_f32_bf16 v208, s72, v133
    v_dot2c_f32_bf16 v209, v133, v133
    v_dot2c_f32_bf16 v208, s72, v134
    v_dot2c_f32_bf16 v209, v134, v134
    v_dot2c_f32_bf16 v208, s72, v135
    v_dot2c_f32_bf16 v209, v135, v135
    s_nop 2
    v_permlane32_swap_b32 v208, v209
    v_add_f32 v5, v208, v209
    ds_write_b32 v65, v5
    v_lshl_add_u32 v7, v8, 10, v9
    s_waitcnt vmcnt(15)
    s_waitcnt lgkmcnt(0)
    s_barrier
    ds_read_b64_tr_b16 v[168:169], v60 offset:0
    ds_read_b64_tr_b16 v[170:171], v60 offset:512
    ds_read_b64_tr_b16 v[172:173], v60 offset:8192
    ds_read_b64_tr_b16 v[174:175], v60 offset:8704
    ds_read_b64_tr_b16 v[176:177], v63 offset:0
    ds_read_b64_tr_b16 v[178:179], v63 offset:512
    ds_read_b64_tr_b16 v[180:181], v63 offset:8192
    ds_read_b64_tr_b16 v[182:183], v63 offset:8704
    ds_read_b64_tr_b16 v[184:185], v60 offset:4096
    ds_read_b64_tr_b16 v[186:187], v60 offset:4608
    ds_read_b64_tr_b16 v[188:189], v60 offset:12288
    ds_read_b64_tr_b16 v[190:191], v60 offset:12800
    s_waitcnt lgkmcnt(8)
    v_mfma_f32_32x32x16_bf16 v[136:151], v[168:171], v[72:75], 0
    ds_read_b64_tr_b16 v[192:193], v63 offset:4096
    ds_read_b64_tr_b16 v[194:195], v63 offset:4608
    v_mfma_f32_32x32x16_bf16 v[152:167], v[72:75], v[172:175], 0
    ds_read_b64_tr_b16 v[196:197], v63 offset:12288
    ds_read_b64_tr_b16 v[198:199], v63 offset:12800
    buffer_load_dwordx4 v15, s[8:11], s80 offen offset:3072 lds
    v_mfma_f32_16x16x32_bf16 v[212:215], v[168:171], a[152:155], 0
    ds_read_b64 v[224:225], v66
    ds_read_b64 v[226:227], v66 offset:512
    v_mfma_f32_16x16x32_bf16 v[216:219], v[172:175], a[152:155], 0
    s_waitcnt lgkmcnt(10)
    v_mfma_f32_32x32x16_bf16 v[136:151], v[176:179], a[0:3], v[136:151]
    s_waitcnt vmcnt(12)
    s_barrier
    ds_read_b64_tr_b16 v[200:201], v60 offset:16384
    ds_read_b64_tr_b16 v[202:203], v60 offset:16896
    s_xor_b32 s84, s83, 5
    s_mul_i32 s84, s84, 196608
    s_add_u32 s84, s84, s73
    s_add_u32 m0, s74, 0x0
    s_add_u32 s80, s84, 0x0
    buffer_load_dwordx4 v12, s[8:11], s80 offen lds
    v_mfma_f32_32x32x16_bf16 v[152:167], a[0:3], v[180:183], v[152:167]
    ds_read_b64_tr_b16 v[204:205], v60 offset:24576
    ds_read_b64_tr_b16 v[206:207], v60 offset:25088
    buffer_load_dwordx4 v13, s[8:11], s80 offen offset:1024 lds
    s_waitcnt lgkmcnt(10)
    v_mfma_f32_32x32x16_bf16 v[136:151], v[184:187], v[76:79], v[136:151]
    ds_read_b64_tr_b16 v[168:169], v63 offset:16384
    ds_read_b64_tr_b16 v[170:171], v63 offset:16896
    v_mfma_f32_32x32x16_bf16 v[152:167], v[76:79], v[188:191], v[152:167]
    ds_read_b64_tr_b16 v[172:173], v63 offset:24576
    ds_read_b64_tr_b16 v[174:175], v63 offset:25088
    buffer_load_dwordx4 v14, s[8:11], s80 offen offset:2048 lds
    v_mfma_f32_16x16x32_bf16 v[212:215], v[184:187], a[152:155], v[212:215]
    v_mfma_f32_16x16x32_bf16 v[216:219], v[188:191], a[152:155], v[216:219]
    s_waitcnt lgkmcnt(10)
    v_mfma_f32_32x32x16_bf16 v[136:151], v[192:195], a[4:7], v[136:151]
    ds_read_b64_tr_b16 v[176:177], v60 offset:20480
    ds_read_b64_tr_b16 v[178:179], v60 offset:20992
    buffer_load_dwordx4 v15, s[8:11], s80 offen offset:3072 lds
    v_mfma_f32_32x32x16_bf16 v[152:167], a[4:7], v[196:199], v[152:167]
    ds_read_b64_tr_b16 v[180:181], v60 offset:28672
    ds_read_b64_tr_b16 v[182:183], v60 offset:29184
    s_xor_b32 s84, s83, 6
    s_mul_i32 s84, s84, 196608
    s_add_u32 s84, s84, s73
    s_add_u32 m0, s74, 0x4000
    s_add_u32 s80, s84, 0x0
    buffer_load_dwordx4 v12, s[8:11], s80 offen lds
    s_waitcnt lgkmcnt(12)
    v_add_f32 v224, v224, v226
    v_add_f32 v225, v225, v227
    s_waitcnt lgkmcnt(8)
    v_mfma_f32_32x32x16_bf16 v[136:151], v[200:203], v[80:83], v[136:151]
    ds_read_b64_tr_b16 v[184:185], v63 offset:20480
    ds_read_b64_tr_b16 v[186:187], v63 offset:20992
    v_mfma_f32_32x32x16_bf16 v[152:167], v[80:83], v[204:207], v[152:167]
    ds_read_b64_tr_b16 v[188:189], v63 offset:28672
    ds_read_b64_tr_b16 v[190:191], v63 offset:29184
    buffer_load_dwordx4 v13, s[8:11], s80 offen offset:1024 lds
    v_mul_f32 v25, 0x3b000000, v224
    v_mul_f32 v5, 0x3b000000, v225
    v_mfma_f32_16x16x32_bf16 v[212:215], v[200:203], a[152:155], v[212:215]
    v_mfma_f32_16x16x32_bf16 v[216:219], v[204:207], a[152:155], v[216:219]
    s_waitcnt lgkmcnt(8)
    v_mfma_f32_32x32x16_bf16 v[136:151], v[168:171], a[8:11], v[136:151]
    s_waitcnt vmcnt(14)
    s_barrier
    ds_read_b64_tr_b16 v[192:193], v59 offset:0
    ds_read_b64_tr_b16 v[194:195], v59 offset:512
    buffer_load_dwordx4 v14, s[8:11], s80 offen offset:2048 lds
    v_mfma_f32_32x32x16_bf16 v[152:167], a[8:11], v[172:175], v[152:167]
    ds_read_b64_tr_b16 v[196:197], v59 offset:8192
    ds_read_b64_tr_b16 v[198:199], v59 offset:8704
    buffer_load_dwordx4 v15, s[8:11], s80 offen offset:3072 lds
    v_fma_f32 v5, -v25, v25, v5
    v_max_f32 v5, 0, v5
    s_waitcnt lgkmcnt(8)
    v_mfma_f32_32x32x16_bf16 v[136:151], v[176:179], v[84:87], v[136:151]
    ds_read_b64_tr_b16 v[200:201], v62 offset:0
    ds_read_b64_tr_b16 v[202:203], v62 offset:512
    v_mfma_f32_32x32x16_bf16 v[152:167], v[84:87], v[180:183], v[152:167]
    ds_read_b64_tr_b16 v[204:205], v62 offset:8192
    ds_read_b64_tr_b16 v[206:207], v62 offset:8704
    s_xor_b32 s84, s83, 7
    s_mul_i32 s84, s84, 196608
    s_add_u32 s84, s84, s73
    s_add_u32 m0, s74, 0x8000
    s_add_u32 s80, s84, 0x0
    buffer_load_dwordx4 v12, s[8:11], s80 offen lds
    v_add_f32 v5, 0x3727c5ac, v5
    v_rsq_f32 v210, v5
    v_mfma_f32_16x16x32_bf16 v[212:215], v[176:179], a[152:155], v[212:215]
    v_mfma_f32_16x16x32_bf16 v[216:219], v[180:183], a[152:155], v[216:219]
    s_waitcnt lgkmcnt(8)
    v_mfma_f32_32x32x16_bf16 v[136:151], v[184:187], a[12:15], v[136:151]
    ds_read_b64_tr_b16 v[168:169], v59 offset:4096
    ds_read_b64_tr_b16 v[170:171], v59 offset:4608
    buffer_load_dwordx4 v13, s[8:11], s80 offen offset:1024 lds
    v_mfma_f32_32x32x16_bf16 v[152:167], a[12:15], v[188:191], v[152:167]
    ds_read_b64_tr_b16 v[172:173], v59 offset:12288
    ds_read_b64_tr_b16 v[174:175], v59 offset:12800
    buffer_load_dwordx4 v14, s[8:11], s80 offen offset:2048 lds
    v_cmp_eq_u32 vcc, 0, v18
    v_mul_f32 v211, -v25, v210
    s_waitcnt lgkmcnt(8)
    v_mfma_f32_32x32x16_bf16 v[136:151], v[192:195], v[88:91], v[136:151]
    ds_read_b64_tr_b16 v[176:177], v62 offset:4096
    ds_read_b64_tr_b16 v[178:179], v62 offset:4608
    v_mfma_f32_32x32x16_bf16 v[152:167], v[88:91], v[196:199], v[152:167]
    ds_read_b64_tr_b16 v[180:181], v62 offset:12288
    ds_read_b64_tr_b16 v[182:183], v62 offset:12800
    buffer_load_dwordx4 v15, s[8:11], s80 offen offset:3072 lds
    buffer_load_dword v3, v10, s[28:31], s77 offen sc1
    v_cndmask_b32 v5, v211, v210, vcc
    ds_write_b32 v70, v5
    v_mfma_f32_16x16x32_bf16 v[212:215], v[192:195], a[152:155], v[212:215]
    v_mfma_f32_16x16x32_bf16 v[216:219], v[196:199], a[152:155], v[216:219]
    s_waitcnt lgkmcnt(9)
    v_mfma_f32_32x32x16_bf16 v[136:151], v[200:203], a[16:19], v[136:151]
    s_waitcnt vmcnt(17)
    s_barrier
    ds_read_b64_tr_b16 v[184:185], v59 offset:16640
    ds_read_b64_tr_b16 v[186:187], v59 offset:17152
    s_lshl_b32 s41, s2, 2
    s_add_u32 s41, s41, s66
    s_lshl_b32 s41, s41, 9
    s_mov_b32 m0, 156928
    s_mov_b32 exec_hi, 0x0
    buffer_load_dwordx4 v2, s[12:15], s41 offen lds
    s_mov_b32 exec_hi, -1
    v_mfma_f32_32x32x16_bf16 v[152:167], a[16:19], v[204:207], v[152:167]
    ds_read_b64_tr_b16 v[188:189], v59 offset:24832
    ds_read_b64_tr_b16 v[190:191], v59 offset:25344
    s_lshr_b32 s69, s12, 7
    s_sub_u32 s69, 3, s69
    s_and_b32 s69, s69, 7
    s_lshl_b32 s69, s69, 7
    s_mul_i32 s41, s0, 4096
    s_add_u32 s41, s41, s69
    s_mov_b32 m0, 156928
    s_mov_b32 exec_hi, 0x0
    buffer_load_dwordx4 v7, s[12:15], s41 offen lds
    s_mov_b32 exec_hi, -1
    s_waitcnt lgkmcnt(9)
    v_mfma_f32_32x32x16_bf16 v[136:151], v[168:171], v[92:95], v[136:151]
    ds_read_b64_tr_b16 v[192:193], v62 offset:16640
    ds_read_b64_tr_b16 v[194:195], v62 offset:17152
    v_mfma_f32_32x32x16_bf16 v[152:167], v[92:95], v[172:175], v[152:167]
    ds_read_b64_tr_b16 v[196:197], v62 offset:24832
    ds_read_b64_tr_b16 v[198:199], v62 offset:25344
    s_xor_b32 s84, s76, 4
    s_mul_i32 s84, s84, 196608
    s_add_u32 s84, s84, s75
    s_add_u32 m0, s74, 0x1c500
    s_add_u32 s80, s84, 0x0
    buffer_load_dwordx4 v12, s[8:11], s80 offen lds
    v_mfma_f32_16x16x32_bf16 v[212:215], v[168:171], a[152:155], v[212:215]
    v_mfma_f32_16x16x32_bf16 v[216:219], v[172:175], a[152:155], v[216:219]
    s_waitcnt lgkmcnt(9)
    v_mfma_f32_32x32x16_bf16 v[136:151], v[176:179], a[20:23], v[136:151]
    ds_read_b64_tr_b16 v[200:201], v59 offset:20736
    ds_read_b64_tr_b16 v[202:203], v59 offset:21248
    buffer_load_dwordx4 v13, s[8:11], s80 offen offset:1024 lds
    v_mfma_f32_32x32x16_bf16 v[152:167], a[20:23], v[180:183], v[152:167]
    ds_read_b64_tr_b16 v[204:205], v59 offset:28928
    ds_read_b64_tr_b16 v[206:207], v59 offset:29440
    buffer_load_dwordx4 v14, s[8:11], s80 offen offset:2048 lds
    s_waitcnt lgkmcnt(8)
    v_mfma_f32_32x32x16_bf16 v[136:151], v[184:187], v[96:99], v[136:151]
    ds_read_b64_tr_b16 v[168:169], v62 offset:20736
    ds_read_b64_tr_b16 v[170:171], v62 offset:21248
    v_mfma_f32_32x32x16_bf16 v[152:167], v[96:99], v[188:191], v[152:167]
    ds_read_b64_tr_b16 v[172:173], v62 offset:28928
    ds_read_b64_tr_b16 v[174:175], v62 offset:29440
    buffer_load_dwordx4 v15, s[8:11], s80 offen offset:3072 lds
    buffer_load_dwordx2 v[16:17], v10, s[32:35], 0 offen sc1
    v_mfma_f32_16x16x32_bf16 v[212:215], v[184:187], a[152:155], v[212:215]
    ds_read_b128 v[224:227], v71 offset:0
    ds_read_b128 v[228:231], v71 offset:32
    ds_read_b128 v[232:235], v71 offset:64
    ds_read_b128 v[236:239], v71 offset:96
    v_mfma_f32_16x16x32_bf16 v[216:219], v[188:191], a[152:155], v[216:219]
    s_waitcnt lgkmcnt(12)
    v_mfma_f32_32x32x16_bf16 v[136:151], v[192:195], a[24:27], v[136:151]
    s_waitcnt vmcnt(20)
    s_barrier
    ds_read_b64_tr_b16 v[176:177], v59 offset:33024
    ds_read_b64_tr_b16 v[178:179], v59 offset:33536
    v_mfma_f32_32x32x16_bf16 v[152:167], a[24:27], v[196:199], v[152:167]
    ds_read_b64_tr_b16 v[180:181], v59 offset:41216
    ds_read_b64_tr_b16 v[182:183], v59 offset:41728
    s_xor_b32 s84, s76, 6
    s_mul_i32 s84, s84, 196608
    s_add_u32 s84, s84, s75
    s_add_u32 m0, s74, 0x20500
    s_add_u32 s80, s84, 0x0
    buffer_load_dwordx4 v12, s[8:11], s80 offen lds
    s_waitcnt lgkmcnt(12)
    v_mfma_f32_32x32x16_bf16 v[136:151], v[200:203], v[100:103], v[136:151]
    ds_read_b64_tr_b16 v[184:185], v62 offset:33024
    ds_read_b64_tr_b16 v[186:187], v62 offset:33536
    v_mfma_f32_32x32x16_bf16 v[152:167], v[100:103], v[204:207], v[152:167]
    ds_read_b64_tr_b16 v[188:189], v62 offset:41216
    ds_read_b64_tr_b16 v[190:191], v62 offset:41728
    buffer_load_dwordx4 v13, s[8:11], s80 offen offset:1024 lds
    v_mfma_f32_16x16x32_bf16 v[212:215], v[200:203], a[152:155], v[212:215]
    ds_read_b128 v[240:243], v71 offset:128
    ds_read_b128 v[244:247], v71 offset:160
    ds_read_b128 v[248:251], v71 offset:192
    ds_read_b128 v[252:255], v71 offset:224
    v_mfma_f32_16x16x32_bf16 v[216:219], v[204:207], a[152:155], v[216:219]
    s_waitcnt lgkmcnt(15)
    v_mfma_f32_32x32x16_bf16 v[136:151], v[168:171], a[28:31], v[136:151]
    ds_read_b64_tr_b16 v[192:193], v59 offset:37120
    ds_read_b64_tr_b16 v[194:195], v59 offset:37632
    buffer_load_dwordx4 v14, s[8:11], s80 offen offset:2048 lds
    v_mfma_f32_32x32x16_bf16 v[152:167], a[28:31], v[172:175], v[152:167]
    ds_read_b64_tr_b16 v[196:197], v59 offset:45312
    ds_read_b64_tr_b16 v[198:199], v59 offset:45824
    buffer_load_dwordx4 v15, s[8:11], s80 offen offset:3072 lds
    s_waitcnt lgkmcnt(12)
    v_mfma_f32_32x32x16_bf16 v[136:151], v[176:179], v[104:107], v[136:151]
    ds_read_b64_tr_b16 v[200:201], v62 offset:37120
    ds_read_b64_tr_b16 v[202:203], v62 offset:37632
    v_mfma_f32_32x32x16_bf16 v[152:167], v[104:107], v[180:183], v[152:167]
    ds_read_b64_tr_b16 v[204:205], v62 offset:45312
    ds_read_b64_tr_b16 v[206:207], v62 offset:45824
    v_mfma_f32_16x16x32_bf16 v[212:215], v[176:179], a[152:155], v[212:215]
    v_mfma_f32_16x16x32_bf16 v[216:219], v[180:183], a[152:155], v[216:219]
    s_waitcnt lgkmcnt(12)
    v_mfma_f32_32x32x16_bf16 v[136:151], v[184:187], a[32:35], v[136:151]
    s_waitcnt vmcnt(20)
    s_barrier
    ds_read_b64_tr_b16 v[168:169], v61 offset:0
    ds_read_b64_tr_b16 v[170:171], v61 offset:512
    v_mfma_f32_32x32x16_bf16 v[152:167], a[32:35], v[188:191], v[152:167]
    ds_read_b64_tr_b16 v[172:173], v61 offset:8192
    ds_read_b64_tr_b16 v[174:175], v61 offset:8704
    s_xor_b32 s84, s76, 0
    s_mul_i32 s84, s84, 196608
    s_add_u32 s84, s84, s75
    s_add_u32 m0, s74, 0x14500
    s_add_u32 s80, s84, 0x0
    buffer_load_dwordx4 v12, s[8:11], s80 offen lds
    s_waitcnt lgkmcnt(8)
    v_mfma_f32_32x32x16_bf16 v[136:151], v[192:195], v[108:111], v[136:151]
    ds_read_b64_tr_b16 v[176:177], v64 offset:0
    ds_read_b64_tr_b16 v[178:179], v64 offset:512
    v_mfma_f32_32x32x16_bf16 v[152:167], v[108:111], v[196:199], v[152:167]
    ds_read_b64_tr_b16 v[180:181], v64 offset:8192
    ds_read_b64_tr_b16 v[182:183], v64 offset:8704
    buffer_load_dwordx4 v13, s[8:11], s80 offen offset:1024 lds
    v_mfma_f32_16x16x32_bf16 v[212:215], v[192:195], a[152:155], v[212:215]
    v_mfma_f32_16x16x32_bf16 v[216:219], v[196:199], a[152:155], v[216:219]
    s_waitcnt lgkmcnt(8)
    v_mfma_f32_32x32x16_bf16 v[136:151], v[200:203], a[36:39], v[136:151]
    ds_read_b64_tr_b16 v[184:185], v61 offset:4096
    ds_read_b64_tr_b16 v[186:187], v61 offset:4608
    buffer_load_dwordx4 v14, s[8:11], s80 offen offset:2048 lds
    v_mfma_f32_32x32x16_bf16 v[152:167], a[36:39], v[204:207], v[152:167]
    ds_read_b64_tr_b16 v[188:189], v61 offset:12288
    ds_read_b64_tr_b16 v[190:191], v61 offset:12800
    buffer_load_dwordx4 v15, s[8:11], s80 offen offset:3072 lds
    s_waitcnt lgkmcnt(8)
    v_mfma_f32_32x32x16_bf16 v[136:151], v[168:171], v[112:115], v[136:151]
    ds_read_b64_tr_b16 v[192:193], v64 offset:4096
    ds_read_b64_tr_b16 v[194:195], v64 offset:4608
    v_mfma_f32_32x32x16_bf16 v[152:167], v[112:115], v[172:175], v[152:167]
    ds_read_b64_tr_b16 v[196:197], v64 offset:12288
    ds_read_b64_tr_b16 v[198:199], v64 offset:12800
    v_mfma_f32_16x16x32_bf16 v[212:215], v[168:171], a[152:155], v[212:215]
    v_mfma_f32_16x16x32_bf16 v[216:219], v[172:175], a[152:155], v[216:219]
    s_waitcnt lgkmcnt(8)
    v_mfma_f32_32x32x16_bf16 v[136:151], v[176:179], a[40:43], v[136:151]
    s_waitcnt vmcnt(20)
    s_barrier
    ds_read_b64_tr_b16 v[200:201], v61 offset:16384
    ds_read_b64_tr_b16 v[202:203], v61 offset:16896
    v_mfma_f32_32x32x16_bf16 v[152:167], a[40:43], v[180:183], v[152:167]
    ds_read_b64_tr_b16 v[204:205], v61 offset:24576
    ds_read_b64_tr_b16 v[206:207], v61 offset:25088
    s_xor_b32 s84, s76, 2
    s_mul_i32 s84, s84, 196608
    s_add_u32 s84, s84, s75
    s_add_u32 m0, s74, 0x18500
    s_add_u32 s80, s84, 0x0
    buffer_load_dwordx4 v12, s[8:11], s80 offen lds
    s_waitcnt lgkmcnt(8)
    v_mfma_f32_32x32x16_bf16 v[136:151], v[184:187], v[116:119], v[136:151]
    ds_read_b64_tr_b16 v[168:169], v64 offset:16384
    ds_read_b64_tr_b16 v[170:171], v64 offset:16896
    v_mfma_f32_32x32x16_bf16 v[152:167], v[116:119], v[188:191], v[152:167]
    ds_read_b64_tr_b16 v[172:173], v64 offset:24576
    ds_read_b64_tr_b16 v[174:175], v64 offset:25088
    buffer_load_dwordx4 v13, s[8:11], s80 offen offset:1024 lds
    v_mfma_f32_16x16x32_bf16 v[212:215], v[184:187], a[152:155], v[212:215]
    v_mfma_f32_16x16x32_bf16 v[216:219], v[188:191], a[152:155], v[216:219]
    s_waitcnt lgkmcnt(8)
    v_mfma_f32_32x32x16_bf16 v[136:151], v[192:195], a[44:47], v[136:151]
    ds_read_b64_tr_b16 v[176:177], v61 offset:20480
    ds_read_b64_tr_b16 v[178:179], v61 offset:20992
    buffer_load_dwordx4 v14, s[8:11], s80 offen offset:2048 lds
    v_mfma_f32_32x32x16_bf16 v[152:167], a[44:47], v[196:199], v[152:167]
    ds_read_b64_tr_b16 v[180:181], v61 offset:28672
    ds_read_b64_tr_b16 v[182:183], v61 offset:29184
    buffer_load_dwordx4 v15, s[8:11], s80 offen offset:3072 lds
    s_waitcnt lgkmcnt(8)
    v_mfma_f32_32x32x16_bf16 v[136:151], v[200:203], v[120:123], v[136:151]
    ds_read_b64_tr_b16 v[184:185], v64 offset:20480
    ds_read_b64_tr_b16 v[186:187], v64 offset:20992
    v_mfma_f32_32x32x16_bf16 v[152:167], v[120:123], v[204:207], v[152:167]
    ds_read_b64_tr_b16 v[188:189], v64 offset:28672
    ds_read_b64_tr_b16 v[190:191], v64 offset:29184
    v_mfma_f32_16x16x32_bf16 v[212:215], v[200:203], a[152:155], v[212:215]
    v_mfma_f32_16x16x32_bf16 v[216:219], v[204:207], a[152:155], v[216:219]
    s_waitcnt lgkmcnt(8)
    v_mfma_f32_32x32x16_bf16 v[136:151], v[168:171], a[48:51], v[136:151]
    s_waitcnt vmcnt(20)
    s_barrier
    ds_read_b64_tr_b16 v[192:193], v61 offset:32768
    ds_read_b64_tr_b16 v[194:195], v61 offset:33280
    v_mfma_f32_32x32x16_bf16 v[152:167], a[48:51], v[172:175], v[152:167]
    ds_read_b64_tr_b16 v[196:197], v61 offset:40960
    ds_read_b64_tr_b16 v[198:199], v61 offset:41472
    s_waitcnt lgkmcnt(8)
    v_mfma_f32_32x32x16_bf16 v[136:151], v[176:179], v[124:127], v[136:151]
    ds_read_b64_tr_b16 v[200:201], v64 offset:32768
    ds_read_b64_tr_b16 v[202:203], v64 offset:33280
    v_mfma_f32_32x32x16_bf16 v[152:167], v[124:127], v[180:183], v[152:167]
    ds_read_b64_tr_b16 v[204:205], v64 offset:40960
    ds_read_b64_tr_b16 v[206:207], v64 offset:41472
    v_mfma_f32_16x16x32_bf16 v[212:215], v[176:179], a[152:155], v[212:215]
    v_mfma_f32_16x16x32_bf16 v[216:219], v[180:183], a[152:155], v[216:219]
    s_waitcnt lgkmcnt(8)
    v_mfma_f32_32x32x16_bf16 v[136:151], v[184:187], a[52:55], v[136:151]
    ds_read_b64_tr_b16 v[168:169], v61 offset:36864
    ds_read_b64_tr_b16 v[170:171], v61 offset:37376
    v_mfma_f32_32x32x16_bf16 v[152:167], a[52:55], v[188:191], v[152:167]
    ds_read_b64_tr_b16 v[172:173], v61 offset:45056
    ds_read_b64_tr_b16 v[174:175], v61 offset:45568
    s_waitcnt lgkmcnt(8)
    v_mfma_f32_32x32x16_bf16 v[136:151], v[192:195], v[128:131], v[136:151]
    ds_read_b64_tr_b16 v[176:177], v64 offset:36864
    ds_read_b64_tr_b16 v[178:179], v64 offset:37376
    v_mfma_f32_32x32x16_bf16 v[152:167], v[128:131], v[196:199], v[152:167]
    ds_read_b64_tr_b16 v[180:181], v64 offset:45056
    ds_read_b64_tr_b16 v[182:183], v64 offset:45568
    v_mfma_f32_16x16x32_bf16 v[212:215], v[192:195], a[152:155], v[212:215]
    v_mfma_f32_16x16x32_bf16 v[216:219], v[196:199], a[152:155], v[216:219]
    s_waitcnt lgkmcnt(8)
    v_mfma_f32_32x32x16_bf16 v[136:151], v[200:203], a[56:59], v[136:151]
    v_mfma_f32_32x32x16_bf16 v[152:167], a[56:59], v[204:207], v[152:167]
    s_waitcnt lgkmcnt(4)
    v_mfma_f32_32x32x16_bf16 v[136:151], v[168:171], v[132:135], v[136:151]
    v_mfma_f32_32x32x16_bf16 v[152:167], v[132:135], v[172:175], v[152:167]
    v_mfma_f32_16x16x32_bf16 v[212:215], v[168:171], a[152:155], v[212:215]
    v_mfma_f32_16x16x32_bf16 v[216:219], v[172:175], a[152:155], v[216:219]
    s_waitcnt lgkmcnt(0)
    v_mfma_f32_32x32x16_bf16 v[136:151], v[176:179], a[60:63], v[136:151]
    v_mfma_f32_32x32x16_bf16 v[152:167], a[60:63], v[180:183], v[152:167]
    s_mov_b32 exec_lo, s42
    s_mov_b32 exec_hi, s42
    s_nop 1
    ds_write_b128 v67, v[212:215] offset:0
    ds_write_b128 v67, v[216:219] offset:256
    s_mov_b64 exec, -1
    s_waitcnt vmcnt(8)
    s_waitcnt lgkmcnt(0)
    s_barrier
    ds_read_b32 v56, v69
    ds_read_b32 v57, v69 offset:1024
    ds_read_b128 v[168:171], v68 offset:0
    ds_read_b128 v[184:187], v68 offset:1024
    ds_read_b128 v[172:175], v68 offset:32
    ds_read_b128 v[188:191], v68 offset:1056
    ds_read_b128 v[176:179], v68 offset:64
    ds_read_b128 v[192:195], v68 offset:1088
    ds_read_b128 v[180:183], v68 offset:96
    ds_read_b128 v[196:199], v68 offset:1120
    s_waitcnt lgkmcnt(8)
    v_add_f32 v56, v56, v57
    v_pk_mul_f32 v[240:241], v[240:241], v[56:57] op_sel_hi:[1,0]
    v_pk_mul_f32 v[242:243], v[242:243], v[56:57] op_sel_hi:[1,0]
    v_pk_mul_f32 v[244:245], v[244:245], v[56:57] op_sel_hi:[1,0]
    v_pk_mul_f32 v[246:247], v[246:247], v[56:57] op_sel_hi:[1,0]
    v_pk_mul_f32 v[248:249], v[248:249], v[56:57] op_sel_hi:[1,0]
    v_pk_mul_f32 v[250:251], v[250:251], v[56:57] op_sel_hi:[1,0]
    v_pk_mul_f32 v[252:253], v[252:253], v[56:57] op_sel_hi:[1,0]
    v_pk_mul_f32 v[254:255], v[254:255], v[56:57] op_sel_hi:[1,0]
    s_waitcnt lgkmcnt(6)
    v_pk_add_f32 v[168:169], v[168:169], v[184:185]
    v_pk_add_f32 v[170:171], v[170:171], v[186:187]
    s_waitcnt lgkmcnt(4)
    v_pk_add_f32 v[172:173], v[172:173], v[188:189]
    v_pk_add_f32 v[174:175], v[174:175], v[190:191]
    s_waitcnt lgkmcnt(2)
    v_pk_add_f32 v[176:177], v[176:177], v[192:193]
    v_pk_add_f32 v[178:179], v[178:179], v[194:195]
    s_waitcnt lgkmcnt(0)
    v_pk_add_f32 v[180:181], v[180:181], v[196:197]
    v_pk_add_f32 v[182:183], v[182:183], v[198:199]
    v_pk_mul_f32 v[168:169], v[168:169], v[210:211] op_sel:[0,1] op_sel_hi:[1,1]
    v_pk_mul_f32 v[170:171], v[170:171], v[210:211] op_sel:[0,1] op_sel_hi:[1,1]
    v_pk_mul_f32 v[172:173], v[172:173], v[210:211] op_sel:[0,1] op_sel_hi:[1,1]
    v_pk_mul_f32 v[174:175], v[174:175], v[210:211] op_sel:[0,1] op_sel_hi:[1,1]
    v_pk_mul_f32 v[176:177], v[176:177], v[210:211] op_sel:[0,1] op_sel_hi:[1,1]
    v_pk_mul_f32 v[178:179], v[178:179], v[210:211] op_sel:[0,1] op_sel_hi:[1,1]
    v_pk_mul_f32 v[180:181], v[180:181], v[210:211] op_sel:[0,1] op_sel_hi:[1,1]
    v_pk_mul_f32 v[182:183], v[182:183], v[210:211] op_sel:[0,1] op_sel_hi:[1,1]
    v_pk_fma_f32 v[136:137], v[136:137], v[210:211], v[168:169] op_sel_hi:[1,0,1]
    v_pk_fma_f32 v[138:139], v[138:139], v[210:211], v[170:171] op_sel_hi:[1,0,1]
    v_pk_fma_f32 v[140:141], v[140:141], v[210:211], v[172:173] op_sel_hi:[1,0,1]
    v_pk_fma_f32 v[142:143], v[142:143], v[210:211], v[174:175] op_sel_hi:[1,0,1]
    v_pk_fma_f32 v[144:145], v[144:145], v[210:211], v[176:177] op_sel_hi:[1,0,1]
    v_pk_fma_f32 v[146:147], v[146:147], v[210:211], v[178:179] op_sel_hi:[1,0,1]
    v_pk_fma_f32 v[148:149], v[148:149], v[210:211], v[180:181] op_sel_hi:[1,0,1]
    v_pk_fma_f32 v[150:151], v[150:151], v[210:211], v[182:183] op_sel_hi:[1,0,1]
    v_cvt_pk_bf16_f32 v168, v136, v137
    v_cvt_pk_bf16_f32 v169, v138, v139
    v_cvt_pk_bf16_f32 v170, v140, v141
    v_cvt_pk_bf16_f32 v171, v142, v143
    v_cvt_pk_bf16_f32 v172, v144, v145
    v_cvt_pk_bf16_f32 v173, v146, v147
    v_cvt_pk_bf16_f32 v174, v148, v149
    v_cvt_pk_bf16_f32 v175, v150, v151
    buffer_store_dwordx4 v[168:171], v2, s[36:39], s43 offen offset:0 sc1
    buffer_store_dwordx4 v[172:175], v2, s[36:39], s43 offen offset:1024 sc1
    v_pk_fma_f32 v[152:153], v[152:153], v[224:225], v[240:241]
    v_pk_fma_f32 v[154:155], v[154:155], v[226:227], v[242:243]
    v_pk_fma_f32 v[156:157], v[156:157], v[228:229], v[244:245]
    v_pk_fma_f32 v[158:159], v[158:159], v[230:231], v[246:247]
    v_pk_fma_f32 v[160:161], v[160:161], v[232:233], v[248:249]
    v_pk_fma_f32 v[162:163], v[162:163], v[234:235], v[250:251]
    v_pk_fma_f32 v[164:165], v[164:165], v[236:237], v[252:253]
    v_pk_fma_f32 v[166:167], v[166:167], v[238:239], v[254:255]
    v_cvt_pk_bf16_f32 v176, v152, v153
    v_cvt_pk_bf16_f32 v177, v154, v155
    v_cvt_pk_bf16_f32 v178, v156, v157
    v_cvt_pk_bf16_f32 v179, v158, v159
    v_cvt_pk_bf16_f32 v180, v160, v161
    v_cvt_pk_bf16_f32 v181, v162, v163
    v_cvt_pk_bf16_f32 v182, v164, v165
    v_cvt_pk_bf16_f32 v183, v166, v167
    buffer_store_dwordx4 v[176:179], v2, s[36:39], s43 offen offset:2048 sc1
    buffer_store_dwordx4 v[180:183], v2, s[36:39], s43 offen offset:3072 sc1
    ds_write_b128 v220, v[168:171] offset:0
    ds_write_b128 v220, v[172:175] offset:1040
    ds_write_b128 v220, v[176:179] offset:2080
    ds_write_b128 v220, v[180:183] offset:3120
    s_mov_b32 exec_lo, 0
    ds_write_b128 v26, v[44:47] offset:3104
    s_mov_b64 exec, -1
    ds_read_b64_tr_b16 v[200:201], v60 offset:0
    ds_read_b64_tr_b16 v[202:203], v60 offset:512
    ds_read_b64_tr_b16 v[204:205], v63 offset:0
    ds_read_b64_tr_b16 v[206:207], v63 offset:512
    ds_read_b64_tr_b16 v[216:217], v60 offset:4096
    ds_read_b64_tr_b16 v[218:219], v60 offset:4608
    ds_read_b64_tr_b16 v[220:221], v63 offset:4096
    ds_read_b64_tr_b16 v[222:223], v63 offset:4608
    v_lshl_add_u32 v12, v8, 10, v9
    v_add_u32 v13, 7168, v12
    v_add_u32 v14, 14336, v12
    v_add_u32 v15, 21504, v12
    s_lshl_b32 s43, s66, 17
    s_lshl_b32 s70, s65, 7
    s_add_u32 s43, s43, s70
    s_waitcnt lgkmcnt(6)
    v_mfma_f32_32x32x16_bf16 v[136:151], v[200:203], v[104:107], 0
    ds_read_b64_tr_b16 v[224:225], v60 offset:8192
    ds_read_b64_tr_b16 v[226:227], v60 offset:8704
    s_add_u32 m0, s45, 0x0
    s_add_u32 s80, s43, 0x0
    buffer_load_dwordx4 v12, s[12:15], s80 offen lds
    v_mul_f32 v70, 0x3eb8aa3b, v210
    v_mul_f32 v71, 0x3eb8aa3b, v211
    v_mfma_f32_16x16x32_bf16 v[212:215], v[200:203], a[152:155], 0
    s_waitcnt lgkmcnt(6)
    v_mfma_f32_32x32x16_bf16 v[136:151], v[204:207], a[32:35], v[136:151]
    ds_read_b64_tr_b16 v[228:229], v63 offset:8192
    ds_read_b64_tr_b16 v[230:231], v63 offset:8704
    buffer_load_dwordx4 v13, s[12:15], s80 offen offset:1024 lds
    s_add_u32 s69, s79, 16640
    v_add_u32 v56, s69, v2
    s_waitcnt lgkmcnt(6)
    v_mfma_f32_32x32x16_bf16 v[136:151], v[216:219], v[108:111], v[136:151]
    ds_read_b64_tr_b16 v[200:201], v60 offset:12288
    ds_read_b64_tr_b16 v[202:203], v60 offset:12800
    buffer_load_dwordx4 v14, s[12:15], s80 offen offset:2048 lds
    v_readfirstlane_b32 s58, v16
    v_readfirstlane_b32 s59, v17
    s_mov_b32 s71, 0x40000
    s_cmp_lg_u32 s58, 0
    s_cbranch_scc0 L_nonce_spin_3
L_nonce_ok_2:
    v_mfma_f32_16x16x32_bf16 v[212:215], v[216:219], a[152:155], v[212:215]
    s_waitcnt lgkmcnt(6)
    v_mfma_f32_32x32x16_bf16 v[136:151], v[220:223], a[36:39], v[136:151]
    ds_read_b64_tr_b16 v[204:205], v63 offset:12288
    ds_read_b64_tr_b16 v[206:207], v63 offset:12800
    buffer_load_dwordx4 v15, s[12:15], s80 offen offset:3072 lds
    s_add_u32 s69, s69, 1024
    v_mov_b32 v6, s69
    s_waitcnt lgkmcnt(6)
    v_mfma_f32_32x32x16_bf16 v[136:151], v[224:227], v[112:115], v[136:151]
    ds_read_b64_tr_b16 v[216:217], v60 offset:16384
    ds_read_b64_tr_b16 v[218:219], v60 offset:16896
    s_add_u32 m0, s45, 0x1000
    s_add_u32 s80, s43, 0x8000
    buffer_load_dwordx4 v12, s[12:15], s80 offen lds
    v_and_b32 v7, 16, v1
    v_cmp_eq_u32 vcc, 0, v7
    v_mfma_f32_16x16x32_bf16 v[212:215], v[224:227], a[152:155], v[212:215]
    s_waitcnt lgkmcnt(6)
    v_mfma_f32_32x32x16_bf16 v[136:151], v[228:231], a[40:43], v[136:151]
    ds_read_b64_tr_b16 v[220:221], v63 offset:16384
    ds_read_b64_tr_b16 v[222:223], v63 offset:16896
    buffer_load_dwordx4 v13, s[12:15], s80 offen offset:1024 lds
    v_lshlrev_b32 v54, 2, v18
    v_sub_u32 v54, v54, v11
    s_waitcnt lgkmcnt(6)
    v_mfma_f32_32x32x16_bf16 v[136:151], v[200:203], v[116:119], v[136:151]
    ds_read_b64_tr_b16 v[224:225], v60 offset:20480
    ds_read_b64_tr_b16 v[226:227], v60 offset:20992
    buffer_load_dwordx4 v14, s[12:15], s80 offen offset:2048 lds
    v_cndmask_b32 v57, v6, v56, vcc
    v_cndmask_b32 v58, v56, v6, vcc
    v_mfma_f32_16x16x32_bf16 v[212:215], v[200:203], a[152:155], v[212:215]
    s_waitcnt lgkmcnt(6)
    v_mfma_f32_32x32x16_bf16 v[136:151], v[204:207], a[44:47], v[136:151]
    ds_read_b64_tr_b16 v[228:229], v63 offset:20480
    ds_read_b64_tr_b16 v[230:231], v63 offset:20992
    buffer_load_dwordx4 v15, s[12:15], s80 offen offset:3072 lds
    v_add_u32 v7, 16, v54
    v_mov_b32 v6, 0xf149f2ca
    s_waitcnt lgkmcnt(6)
    v_mfma_f32_32x32x16_bf16 v[136:151], v[216:219], v[120:123], v[136:151]
    ds_read_b64_tr_b16 v[200:201], v60 offset:24576
    ds_read_b64_tr_b16 v[202:203], v60 offset:25088
    s_add_u32 m0, s45, 0x2000
    s_add_u32 s80, s43, 0x10000
    buffer_load_dwordx4 v12, s[12:15], s80 offen lds
    v_cmp_ge_i32 vcc, 0, v54
    v_cmp_ge_i32 s[60:61], -1, v54
    v_mfma_f32_16x16x32_bf16 v[212:215], v[216:219], a[152:155], v[212:215]
    s_waitcnt lgkmcnt(6)
    v_mfma_f32_32x32x16_bf16 v[136:151], v[220:223], a[48:51], v[136:151]
    ds_read_b64_tr_b16 v[204:205], v63 offset:24576
    ds_read_b64_tr_b16 v[206:207], v63 offset:25088
    buffer_load_dwordx4 v13, s[12:15], s80 offen offset:1024 lds
    v_cmp_ge_i32 s[56:57], -2, v54
    v_cndmask_b32 v152, v6, 0, vcc
    s_waitcnt lgkmcnt(6)
    v_mfma_f32_32x32x16_bf16 v[136:151], v[224:227], v[124:127], v[136:151]
    ds_read_b64_tr_b16 v[216:217], v60 offset:28672
    ds_read_b64_tr_b16 v[218:219], v60 offset:29184
    buffer_load_dwordx4 v14, s[12:15], s80 offen offset:2048 lds
    v_cndmask_b32 v153, v6, 0, s[60:61]
    v_cndmask_b32 v154, v6, 0, s[56:57]
    v_mfma_f32_16x16x32_bf16 v[212:215], v[224:227], a[152:155], v[212:215]
    s_waitcnt lgkmcnt(6)
    v_mfma_f32_32x32x16_bf16 v[136:151], v[228:231], a[52:55], v[136:151]
    ds_read_b64_tr_b16 v[220:221], v63 offset:28672
    ds_read_b64_tr_b16 v[222:223], v63 offset:29184
    buffer_load_dwordx4 v15, s[12:15], s80 offen offset:3072 lds
    v_cmp_ge_i32 vcc, -3, v54
    v_cmp_ge_i32 s[60:61], -8, v54
    s_waitcnt lgkmcnt(6)
    v_mfma_f32_32x32x16_bf16 v[136:151], v[200:203], v[128:131], v[136:151]
    s_waitcnt vmcnt(16)
    s_barrier
    ds_read_b64_tr_b16 v[224:225], v59 offset:16640
    ds_read_b64_tr_b16 v[226:227], v59 offset:17152
    s_add_u32 m0, s45, 0x3000
    s_add_u32 s80, s43, 0x18000
    buffer_load_dwordx4 v12, s[12:15], s80 offen lds
    v_cmp_ge_i32 s[56:57], -9, v54
    v_cndmask_b32 v155, v6, 0, vcc
    v_mfma_f32_16x16x32_bf16 v[212:215], v[200:203], a[152:155], v[212:215]
    s_waitcnt lgkmcnt(6)
    v_mfma_f32_32x32x16_bf16 v[136:151], v[204:207], a[56:59], v[136:151]
    ds_read_b64_tr_b16 v[228:229], v62 offset:16640
    ds_read_b64_tr_b16 v[230:231], v62 offset:17152
    buffer_load_dwordx4 v13, s[12:15], s80 offen offset:1024 lds
    v_cndmask_b32 v156, v6, 0, s[60:61]
    v_cndmask_b32 v157, v6, 0, s[56:57]
    s_waitcnt lgkmcnt(6)
    v_mfma_f32_32x32x16_bf16 v[136:151], v[216:219], v[132:135], v[136:151]
    ds_read_b64_tr_b16 v[200:201], v59 offset:20736
    ds_read_b64_tr_b16 v[202:203], v59 offset:21248
    buffer_load_dwordx4 v14, s[12:15], s80 offen offset:2048 lds
    v_cmp_ge_i32 vcc, -10, v54
    v_cmp_ge_i32 s[60:61], -11, v54
    v_mfma_f32_16x16x32_bf16 v[212:215], v[216:219], a[152:155], v[212:215]
    s_waitcnt lgkmcnt(6)
    v_mfma_f32_32x32x16_bf16 v[136:151], v[220:223], a[60:63], v[136:151]
    ds_read_b64_tr_b16 v[204:205], v62 offset:20736
    ds_read_b64_tr_b16 v[206:207], v62 offset:21248
    buffer_load_dwordx4 v15, s[12:15], s80 offen offset:3072 lds
    v_cmp_ge_i32 s[56:57], 0, v7
    v_cndmask_b32 v158, v6, 0, vcc
    s_waitcnt lgkmcnt(6)
    v_mfma_f32_32x32x16_bf16 v[136:151], v[224:227], v[72:75], v[136:151]
    ds_read_b64_tr_b16 v[216:217], v59 offset:24832
    ds_read_b64_tr_b16 v[218:219], v59 offset:25344
    v_cndmask_b32 v159, v6, 0, s[60:61]
    v_cndmask_b32 v160, v6, 0, s[56:57]
    v_mfma_f32_16x16x32_bf16 v[212:215], v[224:227], a[152:155], v[212:215]
    s_waitcnt lgkmcnt(6)
    v_mfma_f32_32x32x16_bf16 v[136:151], v[228:231], a[0:3], v[136:151]
    ds_read_b64_tr_b16 v[220:221], v62 offset:24832
    ds_read_b64_tr_b16 v[222:223], v62 offset:25344
    v_cmp_ge_i32 vcc, -1, v7
    v_cmp_ge_i32 s[60:61], -2, v7
    s_waitcnt lgkmcnt(6)
    v_mfma_f32_32x32x16_bf16 v[136:151], v[200:203], v[76:79], v[136:151]
    ds_read_b64_tr_b16 v[224:225], v59 offset:28928
    ds_read_b64_tr_b16 v[226:227], v59 offset:29440
    v_cmp_ge_i32 s[56:57], -3, v7
    v_cndmask_b32 v161, v6, 0, vcc
    v_mfma_f32_16x16x32_bf16 v[212:215], v[200:203], a[152:155], v[212:215]
    s_waitcnt vmcnt(16)
    buffer_store_dwordx2 v[16:17], v10, s[28:31], s77 offen sc1
    s_waitcnt lgkmcnt(6)
    v_mfma_f32_32x32x16_bf16 v[136:151], v[204:207], a[4:7], v[136:151]
    ds_read_b64_tr_b16 v[228:229], v62 offset:28928
    ds_read_b64_tr_b16 v[230:231], v62 offset:29440
    s_lshl_b32 s41, s2, 2
    s_add_u32 s41, s41, s66
    s_mul_i32 s41, s41, 1792
    s_mov_b32 m0, 156928
    s_mov_b32 exec_hi, 0xffffff
    buffer_load_dwordx4 v2, s[20:23], s41 offen lds
    s_mov_b32 exec_hi, -1
    s_waitcnt lgkmcnt(6)
    v_mfma_f32_32x32x16_bf16 v[136:151], v[216:219], v[80:83], v[136:151]
    ds_read_b64_tr_b16 v[200:201], v59 offset:33024
    ds_read_b64_tr_b16 v[202:203], v59 offset:33536
    v_cndmask_b32 v162, v6, 0, s[60:61]
    v_cndmask_b32 v163, v6, 0, s[56:57]
    v_mfma_f32_16x16x32_bf16 v[212:215], v[216:219], a[152:155], v[212:215]
    s_waitcnt lgkmcnt(6)
    v_mfma_f32_32x32x16_bf16 v[136:151], v[220:223], a[8:11], v[136:151]
    ds_read_b64_tr_b16 v[204:205], v62 offset:33024
    ds_read_b64_tr_b16 v[206:207], v62 offset:33536
    s_add_u32 s41, s41, 896
    s_mov_b32 m0, 156928
    s_mov_b32 exec_hi, 0xffffff
    buffer_load_dwordx4 v2, s[20:23], s41 offen lds
    s_mov_b32 exec_hi, -1
    s_waitcnt lgkmcnt(6)
    v_mfma_f32_32x32x16_bf16 v[136:151], v[224:227], v[84:87], v[136:151]
    ds_read_b64_tr_b16 v[216:217], v59 offset:37120
    ds_read_b64_tr_b16 v[218:219], v59 offset:37632
    s_lshl_b32 s71, s65, 2
    s_add_u32 s71, s71, s66
    s_lshl_b32 s69, s64, 12
    s_lshl_b32 s70, s71, 7
    s_add_u32 s69, s69, s70
    s_add_u32 s69, s69, 0xf00000
    v_writelane_b32 v5, s69, 0
    s_lshr_b32 s69, s71, 1
    s_lshl_b32 s69, s69, 5
    s_add_u32 s69, s69, s64
    s_lshl_b32 s69, s69, 1
    s_and_b32 s70, s71, 1
    s_add_u32 s69, s69, s70
    s_lshl_b32 s69, s69, 7
    s_add_u32 s69, s69, 0x1020000
    v_writelane_b32 v5, s69, 1
    v_writelane_b32 v5, s5, 2
    s_mov_b64 exec, 7
    buffer_load_dword v3, v5, s[28:31], 0 offen sc1
    s_mov_b64 exec, -1
    v_mfma_f32_16x16x32_bf16 v[212:215], v[224:227], a[152:155], v[212:215]
    s_waitcnt lgkmcnt(6)
    v_mfma_f32_32x32x16_bf16 v[136:151], v[228:231], a[12:15], v[136:151]
    ds_read_b64_tr_b16 v[220:221], v62 offset:37120
    ds_read_b64_tr_b16 v[222:223], v62 offset:37632
    s_lshr_b32 s69, s20, 7
    s_sub_u32 s69, 3, s69
    s_and_b32 s69, s69, 7
    s_lshl_b32 s69, s69, 7
    s_mul_i32 s41, s0, 14336
    s_add_u32 s41, s41, s69
    s_mov_b32 m0, 156928
    s_mov_b32 exec_hi, 0xffffff
    buffer_load_dwordx4 v12, s[20:23], s41 offen lds
    s_mov_b32 exec_hi, -1
    s_waitcnt lgkmcnt(6)
    v_mfma_f32_32x32x16_bf16 v[136:151], v[200:203], v[88:91], v[136:151]
    ds_read_b64_tr_b16 v[224:225], v59 offset:41216
    ds_read_b64_tr_b16 v[226:227], v59 offset:41728
    v_cmp_ge_i32 vcc, -8, v7
    v_cmp_ge_i32 s[60:61], -9, v7
    v_mfma_f32_16x16x32_bf16 v[212:215], v[200:203], a[152:155], v[212:215]
    s_waitcnt lgkmcnt(6)
    v_mfma_f32_32x32x16_bf16 v[136:151], v[204:207], a[16:19], v[136:151]
    ds_read_b64_tr_b16 v[228:229], v62 offset:41216
    ds_read_b64_tr_b16 v[230:231], v62 offset:41728
    s_add_u32 s41, s41, 7168
    s_mov_b32 m0, 156928
    s_mov_b32 exec_hi, 0xffffff
    buffer_load_dwordx4 v12, s[20:23], s41 offen lds
    s_mov_b32 exec_hi, -1
    s_waitcnt lgkmcnt(6)
    v_mfma_f32_32x32x16_bf16 v[136:151], v[216:219], v[92:95], v[136:151]
    ds_read_b64_tr_b16 v[200:201], v59 offset:45312
    ds_read_b64_tr_b16 v[202:203], v59 offset:45824
    v_cmp_ge_i32 s[56:57], -10, v7
    v_cndmask_b32 v164, v6, 0, vcc
    v_mfma_f32_16x16x32_bf16 v[212:215], v[216:219], a[152:155], v[212:215]
    s_waitcnt lgkmcnt(6)
    v_mfma_f32_32x32x16_bf16 v[136:151], v[220:223], a[20:23], v[136:151]
    ds_read_b64_tr_b16 v[204:205], v62 offset:45312
    ds_read_b64_tr_b16 v[206:207], v62 offset:45824
    s_lshl_b32 s41, s2, 2
    s_add_u32 s41, s41, s66
    s_mul_i32 s41, s41, 1792
    s_mov_b32 m0, 156928
    s_mov_b32 exec_hi, 0xffffff
    buffer_load_dwordx4 v2, s[16:19], s41 offen lds
    s_mov_b32 exec_hi, -1
    s_waitcnt lgkmcnt(6)
    v_mfma_f32_32x32x16_bf16 v[136:151], v[224:227], v[96:99], v[136:151]
    v_cndmask_b32 v165, v6, 0, s[60:61]
    v_cndmask_b32 v166, v6, 0, s[56:57]
    v_mfma_f32_16x16x32_bf16 v[212:215], v[224:227], a[152:155], v[212:215]
    s_waitcnt lgkmcnt(4)
    v_mfma_f32_32x32x16_bf16 v[136:151], v[228:231], a[24:27], v[136:151]
    s_add_u32 s41, s41, 896
    s_mov_b32 m0, 156928
    s_mov_b32 exec_hi, 0xffffff
    buffer_load_dwordx4 v2, s[16:19], s41 offen lds
    s_mov_b32 exec_hi, -1
    s_waitcnt lgkmcnt(2)
    v_mfma_f32_32x32x16_bf16 v[136:151], v[200:203], v[100:103], v[136:151]
    v_cmp_ge_i32 vcc, -11, v7
    s_nop 1
    v_cndmask_b32 v167, v6, 0, vcc
    v_mfma_f32_16x16x32_bf16 v[212:215], v[200:203], a[152:155], v[212:215]
    s_waitcnt lgkmcnt(0)
    v_mfma_f32_32x32x16_bf16 v[136:151], v[204:207], a[28:31], v[136:151]
    s_mov_b32 exec_lo, s42
    s_mov_b32 exec_hi, s42
    s_nop 3
    ds_write_b128 v67, v[212:215] offset:512
    s_mov_b64 exec, -1
    s_waitcnt vmcnt(8)
    s_waitcnt lgkmcnt(0)
    s_barrier
    ds_read_b128 v[168:171], v68 offset:512
    ds_read_b128 v[184:187], v68 offset:1536
    ds_read_b128 v[172:175], v68 offset:544
    ds_read_b128 v[188:191], v68 offset:1568
    ds_read_b128 v[176:179], v68 offset:576
    ds_read_b128 v[192:195], v68 offset:1600
    ds_read_b128 v[180:183], v68 offset:608
    ds_read_b128 v[196:199], v68 offset:1632
    s_waitcnt lgkmcnt(6)
    v_pk_add_f32 v[168:169], v[168:169], v[184:185]
    v_pk_add_f32 v[170:171], v[170:171], v[186:187]
    s_waitcnt lgkmcnt(4)
    v_pk_add_f32 v[172:173], v[172:173], v[188:189]
    v_pk_add_f32 v[174:175], v[174:175], v[190:191]
    s_waitcnt lgkmcnt(2)
    v_pk_add_f32 v[176:177], v[176:177], v[192:193]
    v_pk_add_f32 v[178:179], v[178:179], v[194:195]
    s_waitcnt lgkmcnt(0)
    v_pk_add_f32 v[180:181], v[180:181], v[196:197]
    v_pk_add_f32 v[182:183], v[182:183], v[198:199]
    v_pk_mul_f32 v[168:169], v[168:169], v[70:71] op_sel:[0,1] op_sel_hi:[1,1]
    v_pk_mul_f32 v[170:171], v[170:171], v[70:71] op_sel:[0,1] op_sel_hi:[1,1]
    v_pk_mul_f32 v[172:173], v[172:173], v[70:71] op_sel:[0,1] op_sel_hi:[1,1]
    v_pk_mul_f32 v[174:175], v[174:175], v[70:71] op_sel:[0,1] op_sel_hi:[1,1]
    v_pk_mul_f32 v[176:177], v[176:177], v[70:71] op_sel:[0,1] op_sel_hi:[1,1]
    v_pk_mul_f32 v[178:179], v[178:179], v[70:71] op_sel:[0,1] op_sel_hi:[1,1]
    v_pk_mul_f32 v[180:181], v[180:181], v[70:71] op_sel:[0,1] op_sel_hi:[1,1]
    v_pk_mul_f32 v[182:183], v[182:183], v[70:71] op_sel:[0,1] op_sel_hi:[1,1]
    v_pk_fma_f32 v[136:137], v[136:137], v[70:71], v[168:169] op_sel_hi:[1,0,1]
    v_pk_fma_f32 v[138:139], v[138:139], v[70:71], v[170:171] op_sel_hi:[1,0,1]
    v_pk_fma_f32 v[140:141], v[140:141], v[70:71], v[172:173] op_sel_hi:[1,0,1]
    v_pk_fma_f32 v[142:143], v[142:143], v[70:71], v[174:175] op_sel_hi:[1,0,1]
    v_pk_fma_f32 v[144:145], v[144:145], v[70:71], v[176:177] op_sel_hi:[1,0,1]
    v_pk_fma_f32 v[146:147], v[146:147], v[70:71], v[178:179] op_sel_hi:[1,0,1]
    v_pk_fma_f32 v[148:149], v[148:149], v[70:71], v[180:181] op_sel_hi:[1,0,1]
    v_pk_fma_f32 v[150:151], v[150:151], v[70:71], v[182:183] op_sel_hi:[1,0,1]
    v_cvt_pk_bf16_f32 v36, v136, v137
    v_cvt_pk_bf16_f32 v37, v138, v139
    v_cvt_pk_bf16_f32 v38, v140, v141
    v_cvt_pk_bf16_f32 v39, v142, v143
    v_cvt_pk_bf16_f32 v40, v144, v145
    v_cvt_pk_bf16_f32 v41, v146, v147
    v_cvt_pk_bf16_f32 v42, v148, v149
    v_cvt_pk_bf16_f32 v43, v150, v151
    s_lshl_b32 s69, s68, 15
    v_xor_b32 v4, s68, v24
    v_lshl_add_u32 v6, v4, 6, v19
    v_mul_u32_u24 v4, 512, v18
    v_add3_u32 v6, v6, v4, s69
    v_xor_b32 v7, 64, v6
    ds_read_b128 a[160:163], v50 offset:0
    ds_read_b128 a[164:167], v51 offset:0
    ds_read_b128 a[168:171], v52 offset:0
    ds_read_b128 a[172:175], v53 offset:0
    ds_read_b128 v[108:111], v56 offset:49920
    ds_read_b128 v[100:103], v56 offset:50960
    ds_read_b128 v[92:95], v57 offset:52000
    ds_read_b128 v[96:99], v57 offset:53040
    s_waitcnt lgkmcnt(3)
    v_mfma_f32_32x32x16_bf16 v[60:75], v[108:111], v[36:39], v[152:167]
    ds_read_b128 a[176:179], v50 offset:4096
    ds_read_b128 a[180:183], v51 offset:4096
    ds_read_b64_tr_b16 v[112:113], v6 offset:0
    ds_read_b64_tr_b16 v[114:115], v6 offset:1024
    ds_read_b64_tr_b16 v[116:117], v7 offset:0
    ds_read_b64_tr_b16 v[118:119], v7 offset:1024
    ds_read_b64_tr_b16 v[120:121], v6 offset:2048
    ds_read_b64_tr_b16 v[122:123], v6 offset:3072
    ds_read_b64_tr_b16 v[124:125], v7 offset:2048
    ds_read_b64_tr_b16 v[126:127], v7 offset:3072
    s_add_u32 m0, s45, 0x14500
    s_add_u32 s80, s44, 0x0
    buffer_load_dwordx4 v12, s[20:23], s80 offen lds
    v_mfma_f32_32x32x16_bf16 a[96:111], a[156:159], a[160:163], 0
    v_mfma_f32_32x32x16_bf16 a[96:111], a[156:159], a[164:167], a[96:111]
    s_waitcnt lgkmcnt(12)
    v_mfma_f32_32x32x16_bf16 v[76:91], v[100:103], v[40:43], v[152:167]
    ds_read_b128 a[184:187], v52 offset:4096
    ds_read_b128 a[188:191], v53 offset:4096
    ds_read_b64_tr_b16 v[128:129], v6 offset:4096
    ds_read_b64_tr_b16 v[130:131], v6 offset:5120
    ds_read_b64_tr_b16 v[132:133], v7 offset:4096
    ds_read_b64_tr_b16 v[134:135], v7 offset:5120
    ds_read_b64_tr_b16 v[136:137], v6 offset:6144
    ds_read_b64_tr_b16 v[138:139], v6 offset:7168
    ds_read_b64_tr_b16 v[140:141], v7 offset:6144
    ds_read_b64_tr_b16 v[142:143], v7 offset:7168
    buffer_load_dwordx4 v13, s[20:23], s80 offen offset:1024 lds
    v_mfma_f32_32x32x16_bf16 a[96:111], a[156:159], a[168:171], a[96:111]
    v_mfma_f32_32x32x16_bf16 a[96:111], a[156:159], a[172:175], a[96:111]
    ds_read_b128 v[100:103], v58 offset:52000
    ds_read_b128 v[104:107], v58 offset:53040
    v_exp_f32 v60, v60
    v_exp_f32 v61, v61
    v_exp_f32 v62, v62
    v_exp_f32 v63, v63
    v_exp_f32 v64, v64
    v_exp_f32 v65, v65
    v_exp_f32 v66, v66
    v_exp_f32 v67, v67
    v_exp_f32 v68, v68
    v_exp_f32 v69, v69
    v_cvt_pk_bf16_f32 v60, v60, v61
    v_cvt_pk_bf16_f32 v61, v62, v63
    v_cvt_pk_bf16_f32 v62, v64, v65
    v_cvt_pk_bf16_f32 v63, v66, v67
    v_exp_f32 v70, v70
    v_exp_f32 v71, v71
    s_waitcnt lgkmcnt(15)
    v_mfma_f32_32x32x16_bf16 a[224:239], v[92:95], v[60:63], 0
    ds_read_b128 a[160:163], v50 offset:8192
    ds_read_b128 a[164:167], v51 offset:8192
    ds_read_b64_tr_b16 v[144:145], v6 offset:8192
    ds_read_b64_tr_b16 v[146:147], v6 offset:9216
    ds_read_b64_tr_b16 v[148:149], v7 offset:8192
    ds_read_b64_tr_b16 v[150:151], v7 offset:9216
    ds_read_b64_tr_b16 v[168:169], v6 offset:10240
    ds_read_b64_tr_b16 v[170:171], v6 offset:11264
    ds_read_b64_tr_b16 v[172:173], v7 offset:10240
    ds_read_b64_tr_b16 v[174:175], v7 offset:11264
    buffer_load_dwordx4 v14, s[20:23], s80 offen offset:2048 lds
    buffer_load_dwordx4 v15, s[20:23], s80 offen offset:3072 lds
    v_mfma_f32_32x32x16_bf16 a[112:127], a[156:159], a[176:179], 0
    v_mfma_f32_32x32x16_bf16 a[112:127], a[156:159], a[180:183], a[112:127]
    v_exp_f32 v72, v72
    v_exp_f32 v73, v73
    v_exp_f32 v74, v74
    v_exp_f32 v75, v75
    v_exp_f32 v76, v76
    v_exp_f32 v77, v77
    v_cvt_pk_bf16_f32 v64, v68, v69
    v_cvt_pk_bf16_f32 v65, v70, v71
    v_cvt_pk_bf16_f32 v66, v72, v73
    v_cvt_pk_bf16_f32 v67, v74, v75
    v_exp_f32 v78, v78
    v_exp_f32 v79, v79
    v_mfma_f32_32x32x16_bf16 a[224:239], v[96:99], v[64:67], a[224:239]
    ds_read_b128 a[168:171], v52 offset:8192
    ds_read_b128 a[172:175], v53 offset:8192
    ds_read_b64_tr_b16 v[176:177], v6 offset:12288
    ds_read_b64_tr_b16 v[178:179], v6 offset:13312
    ds_read_b64_tr_b16 v[180:181], v7 offset:12288
    ds_read_b64_tr_b16 v[182:183], v7 offset:13312
    ds_read_b64_tr_b16 v[184:185], v6 offset:14336
    ds_read_b64_tr_b16 v[186:187], v6 offset:15360
    ds_read_b64_tr_b16 v[188:189], v7 offset:14336
    ds_read_b64_tr_b16 v[190:191], v7 offset:15360
    s_add_u32 m0, s45, 0x15500
    s_add_u32 s80, s44, 0x8000
    buffer_load_dwordx4 v12, s[20:23], s80 offen lds
    s_waitcnt lgkmcnt(15)
    v_mfma_f32_32x32x16_bf16 a[112:127], a[156:159], a[184:187], a[112:127]
    v_mfma_f32_32x32x16_bf16 a[112:127], a[156:159], a[188:191], a[112:127]
    v_exp_f32 v80, v80
    v_exp_f32 v81, v81
    v_exp_f32 v82, v82
    v_exp_f32 v83, v83
    s_mov_b64 exec, 0xff
    buffer_load_dwordx4 v[20:23], v49, s[28:31], s48 offen sc1
    s_mov_b64 exec, -1
    ds_read_b128 a[176:179], v50 offset:12288
    ds_read_b128 a[180:183], v51 offset:12288
    ds_read_b64_tr_b16 v[192:193], v6 offset:16384
    ds_read_b64_tr_b16 v[194:195], v6 offset:17408
    ds_read_b64_tr_b16 v[196:197], v7 offset:16384
    ds_read_b64_tr_b16 v[198:199], v7 offset:17408
    ds_read_b64_tr_b16 v[200:201], v6 offset:18432
    ds_read_b64_tr_b16 v[202:203], v6 offset:19456
    ds_read_b64_tr_b16 v[204:205], v7 offset:18432
    ds_read_b64_tr_b16 v[206:207], v7 offset:19456
    buffer_load_dwordx4 v13, s[20:23], s80 offen offset:1024 lds
    buffer_load_dwordx4 v14, s[20:23], s80 offen offset:2048 lds
    v_mfma_f32_32x32x16_bf16 a[192:207], a[156:159], a[160:163], 0
    v_mfma_f32_32x32x16_bf16 a[192:207], a[156:159], a[164:167], a[192:207]
    v_exp_f32 v84, v84
    v_exp_f32 v85, v85
    v_cvt_pk_bf16_f32 v76, v76, v77
    v_cvt_pk_bf16_f32 v77, v78, v79
    v_cvt_pk_bf16_f32 v78, v80, v81
    v_cvt_pk_bf16_f32 v79, v82, v83
    v_exp_f32 v86, v86
    v_exp_f32 v87, v87
    v_mfma_f32_32x32x16_bf16 a[240:255], v[100:103], v[76:79], 0
    ds_read_b128 a[184:187], v52 offset:12288
    ds_read_b128 a[188:191], v53 offset:12288
    ds_read_b64_tr_b16 v[208:209], v6 offset:20480
    ds_read_b64_tr_b16 v[210:211], v6 offset:21504
    ds_read_b64_tr_b16 v[212:213], v7 offset:20480
    ds_read_b64_tr_b16 v[214:215], v7 offset:21504
    ds_read_b64_tr_b16 v[216:217], v6 offset:22528
    ds_read_b64_tr_b16 v[218:219], v6 offset:23552
    ds_read_b64_tr_b16 v[220:221], v7 offset:22528
    ds_read_b64_tr_b16 v[222:223], v7 offset:23552
    buffer_load_dwordx4 v15, s[20:23], s80 offen offset:3072 lds
    s_add_u32 m0, s45, 0x16500
    s_add_u32 s80, s44, 0x10000
    buffer_load_dwordx4 v12, s[20:23], s80 offen lds
    s_waitcnt lgkmcnt(15)
    v_mfma_f32_32x32x16_bf16 a[192:207], a[156:159], a[168:171], a[192:207]
    v_mfma_f32_32x32x16_bf16 a[192:207], a[156:159], a[172:175], a[192:207]
    v_exp_f32 v88, v88
    v_exp_f32 v89, v89
    v_exp_f32 v90, v90
    v_exp_f32 v91, v91
    v_cvt_pk_bf16_f32 v80, v84, v85
    v_cvt_pk_bf16_f32 v81, v86, v87
    v_cvt_pk_bf16_f32 v82, v88, v89
    v_cvt_pk_bf16_f32 v83, v90, v91
    s_nop 1
    v_mfma_f32_32x32x16_bf16 a[240:255], v[104:107], v[80:83], a[240:255]
    ds_read_b64_tr_b16 v[224:225], v6 offset:24576
    ds_read_b64_tr_b16 v[226:227], v6 offset:25600
    ds_read_b64_tr_b16 v[228:229], v7 offset:24576
    ds_read_b64_tr_b16 v[230:231], v7 offset:25600
    ds_read_b64_tr_b16 v[232:233], v6 offset:26624
    ds_read_b64_tr_b16 v[234:235], v6 offset:27648
    ds_read_b64_tr_b16 v[236:237], v7 offset:26624
    ds_read_b64_tr_b16 v[238:239], v7 offset:27648
    buffer_load_dwordx4 v13, s[20:23], s80 offen offset:1024 lds
    v_mfma_f32_32x32x16_bf16 a[208:223], a[156:159], a[176:179], 0
    v_mfma_f32_32x32x16_bf16 a[208:223], a[156:159], a[180:183], a[208:223]
    ds_read_b64_tr_b16 v[240:241], v6 offset:28672
    ds_read_b64_tr_b16 v[242:243], v6 offset:29696
    ds_read_b64_tr_b16 v[244:245], v7 offset:28672
    ds_read_b64_tr_b16 v[246:247], v7 offset:29696
    ds_read_b64_tr_b16 v[248:249], v6 offset:30720
    ds_read_b64_tr_b16 v[250:251], v6 offset:31744
    ds_read_b64_tr_b16 v[252:253], v7 offset:30720
    ds_read_b64_tr_b16 v[254:255], v7 offset:31744
    buffer_load_dwordx4 v14, s[20:23], s80 offen offset:2048 lds
    buffer_load_dwordx4 v15, s[20:23], s80 offen offset:3072 lds
    s_waitcnt lgkmcnt(15)
    v_mfma_f32_32x32x16_bf16 a[208:223], a[156:159], a[184:187], a[208:223]
    v_mfma_f32_32x32x16_bf16 a[208:223], a[156:159], a[188:191], a[208:223]
    v_cmp_eq_u32 vcc, 0, v18
    v_sub_f32 v152, 0xf149f2ca, v152
    v_sub_f32 v153, 0xf149f2ca, v153
    v_sub_f32 v154, 0xf149f2ca, v154
    v_sub_f32 v155, 0xf149f2ca, v155
    v_sub_f32 v156, 0xf149f2ca, v156
    v_sub_f32 v157, 0xf149f2ca, v157
    v_sub_f32 v158, 0xf149f2ca, v158
    v_sub_f32 v159, 0xf149f2ca, v159
    v_sub_f32 v160, 0xf149f2ca, v160
    v_sub_f32 v161, 0xf149f2ca, v161
    v_sub_f32 v162, 0xf149f2ca, v162
    v_sub_f32 v163, 0xf149f2ca, v163
    v_sub_f32 v164, 0xf149f2ca, v164
    v_sub_f32 v165, 0xf149f2ca, v165
    v_sub_f32 v166, 0xf149f2ca, v166
    v_sub_f32 v167, 0xf149f2ca, v167
    v_accvgpr_read_b32 v4, a96
    v_accvgpr_read_b32 v5, a112
    v_accvgpr_read_b32 v6, a192
    v_accvgpr_read_b32 v7, a208
    v_cndmask_b32 v4, v5, v4, vcc
    v_cndmask_b32 v5, v7, v6, vcc
    v_lshlrev_b32 v6, 2, v1
    buffer_store_dword v4, v6, s[28:31], s47 offen sc1
    buffer_store_dword v5, v6, s[28:31], s47 offen offset:256 sc1
    s_waitcnt lgkmcnt(0)
    s_barrier
    s_mov_b32 exec_hi, 0
    ds_write_b128 v26, v[44:47] offset:3104
    s_mov_b64 exec, -1
    s_waitcnt vmcnt(9)
    s_mov_b64 exec, 0xff
    v_cmp_ne_u64 vcc, s[58:59], v[20:21]
    v_cmp_ne_u64 s[60:61], s[58:59], v[22:23]
    s_mov_b64 exec, -1
    s_or_b32 s70, vcc_lo, s60
    s_cbranch_scc0 L_spin_kv_4_d
    s_mov_b32 s71, 0x40000
L_spin_kv_4_l:
    s_mov_b64 exec, 0xff
    buffer_load_dwordx4 v[20:23], v49, s[28:31], s48 offen sc1
    s_waitcnt vmcnt(0)
    v_cmp_ne_u64 vcc, s[58:59], v[20:21]
    v_cmp_ne_u64 s[60:61], s[58:59], v[22:23]
    s_mov_b64 exec, -1
    s_or_b32 s70, vcc_lo, s60
    s_cbranch_scc0 L_spin_kv_4_d
    s_sub_u32 s71, s71, 1
    s_cbranch_scc0 L_spin_kv_4_l
L_spin_kv_4_d:
    s_add_u32 m0, s49, 49920
    s_lshl_b32 s70, s66, 12
    s_cmp_ge_u32 s64, 1
    s_cselect_b32 s69, s70, 0x40000000
    v_add_u32 v49, s69, v2
    s_sub_i32 s80, s64, 1
    s_max_i32 s80, s80, 0
    s_lshl_b32 s80, s80, 17
    buffer_load_dwordx4 v49, s[36:39], s80 offen sc1 lds
    s_add_u32 m0, s49, 49936
    s_nop 0
    buffer_load_dwordx4 v49, s[36:39], s80 offen offset:1024 sc1 lds
    s_add_u32 m0, s49, 49952
    s_nop 0
    buffer_load_dwordx4 v49, s[36:39], s80 offen offset:2048 sc1 lds
    s_add_u32 m0, s49, 49968
    s_nop 0
    buffer_load_dwordx4 v49, s[36:39], s80 offen offset:3072 sc1 lds
    s_add_u32 m0, s49, 33280
    s_lshl_b32 s70, s66, 12
    s_cmp_ge_u32 s64, 2
    s_cselect_b32 s69, s70, 0x40000000
    v_add_u32 v49, s69, v2
    s_sub_i32 s80, s64, 2
    s_max_i32 s80, s80, 0
    s_lshl_b32 s80, s80, 17
    buffer_load_dwordx4 v49, s[36:39], s80 offen sc1 lds
    s_add_u32 m0, s49, 33296
    s_nop 0
    buffer_load_dwordx4 v49, s[36:39], s80 offen offset:1024 sc1 lds
    s_add_u32 m0, s49, 33312
    s_nop 0
    buffer_load_dwordx4 v49, s[36:39], s80 offen offset:2048 sc1 lds
    s_add_u32 m0, s49, 33328
    s_nop 0
    buffer_load_dwordx4 v49, s[36:39], s80 offen offset:3072 sc1 lds
    s_add_u32 m0, s49, 16640
    s_lshl_b32 s70, s66, 12
    s_cmp_ge_u32 s64, 3
    s_cselect_b32 s69, s70, 0x40000000
    v_add_u32 v49, s69, v2
    s_sub_i32 s80, s64, 3
    s_max_i32 s80, s80, 0
    s_lshl_b32 s80, s80, 17
    buffer_load_dwordx4 v49, s[36:39], s80 offen sc1 lds
    s_add_u32 m0, s49, 16656
    s_nop 0
    buffer_load_dwordx4 v49, s[36:39], s80 offen offset:1024 sc1 lds
    s_waitcnt vmcnt(6)
    s_waitcnt lgkmcnt(0)
    s_barrier
    ds_read_b128 v[108:111], v56 offset:41600
    ds_read_b128 v[100:103], v56 offset:42640
    ds_read_b128 v[92:95], v57 offset:43680
    ds_read_b128 v[96:99], v57 offset:44720
    s_waitcnt lgkmcnt(3)
    v_mfma_f32_32x32x16_bf16 v[60:75], v[108:111], v[36:39], 0
    s_add_u32 m0, s49, 16672
    s_nop 0
    buffer_load_dwordx4 v49, s[36:39], s80 offen offset:2048 sc1 lds
    s_waitcnt lgkmcnt(2)
    v_mfma_f32_32x32x16_bf16 v[76:91], v[100:103], v[40:43], 0
    s_add_u32 m0, s49, 16688
    s_nop 0
    buffer_load_dwordx4 v49, s[36:39], s80 offen offset:3072 sc1 lds
    ds_read_b128 v[100:103], v58 offset:43680
    ds_read_b128 v[104:107], v58 offset:44720
    s_nop 1
    v_exp_f32 v60, v60
    v_exp_f32 v61, v61
    v_exp_f32 v62, v62
    v_exp_f32 v63, v63
    v_exp_f32 v64, v64
    v_exp_f32 v65, v65
    v_exp_f32 v66, v66
    v_exp_f32 v67, v67
    v_exp_f32 v68, v68
    v_exp_f32 v69, v69
    v_cvt_pk_bf16_f32 v60, v60, v61
    v_cvt_pk_bf16_f32 v61, v62, v63
    v_cvt_pk_bf16_f32 v62, v64, v65
    v_cvt_pk_bf16_f32 v63, v66, v67
    v_exp_f32 v70, v70
    v_exp_f32 v71, v71
    s_waitcnt lgkmcnt(3)
    v_mfma_f32_32x32x16_bf16 a[224:239], v[92:95], v[60:63], a[224:239]
    ds_read_b128 v[108:111], v56 offset:33280
    s_add_u32 m0, s49, 0
    s_lshl_b32 s70, s66, 12
    s_cmp_ge_u32 s64, 4
    s_cselect_b32 s69, s70, 0x40000000
    v_add_u32 v49, s69, v2
    s_sub_i32 s80, s64, 4
    s_max_i32 s80, s80, 0
    s_lshl_b32 s80, s80, 17
    buffer_load_dwordx4 v49, s[36:39], s80 offen sc1 lds
    v_exp_f32 v72, v72
    v_exp_f32 v73, v73
    v_exp_f32 v74, v74
    v_exp_f32 v75, v75
    v_exp_f32 v76, v76
    v_exp_f32 v77, v77
    v_cvt_pk_bf16_f32 v64, v68, v69
    v_cvt_pk_bf16_f32 v65, v70, v71
    v_cvt_pk_bf16_f32 v66, v72, v73
    v_cvt_pk_bf16_f32 v67, v74, v75
    v_exp_f32 v78, v78
    v_exp_f32 v79, v79
    s_waitcnt lgkmcnt(3)
    v_mfma_f32_32x32x16_bf16 a[224:239], v[96:99], v[64:67], a[224:239]
    s_add_u32 m0, s49, 16
    s_nop 0
    buffer_load_dwordx4 v49, s[36:39], s80 offen offset:1024 sc1 lds
    v_exp_f32 v80, v80
    v_exp_f32 v81, v81
    v_exp_f32 v82, v82
    v_exp_f32 v83, v83
    s_waitcnt lgkmcnt(0)
    v_mfma_f32_32x32x16_bf16 v[60:75], v[108:111], v[36:39], 0
    ds_read_b128 v[92:95], v57 offset:35360
    ds_read_b128 v[96:99], v57 offset:36400
    s_add_u32 m0, s49, 32
    s_nop 0
    buffer_load_dwordx4 v49, s[36:39], s80 offen offset:2048 sc1 lds
    s_add_u32 m0, s49, 48
    s_nop 0
    buffer_load_dwordx4 v49, s[36:39], s80 offen offset:3072 sc1 lds
    v_exp_f32 v84, v84
    v_exp_f32 v85, v85
    v_cvt_pk_bf16_f32 v76, v76, v77
    v_cvt_pk_bf16_f32 v77, v78, v79
    v_cvt_pk_bf16_f32 v78, v80, v81
    v_cvt_pk_bf16_f32 v79, v82, v83
    v_exp_f32 v86, v86
    v_exp_f32 v87, v87
    v_mfma_f32_32x32x16_bf16 a[240:255], v[100:103], v[76:79], a[240:255]
    ds_read_b128 v[108:111], v56 offset:34320
    s_add_u32 m0, s45, 0x17500
    s_add_u32 s80, s44, 0x18000
    buffer_load_dwordx4 v12, s[20:23], s80 offen lds
    v_exp_f32 v88, v88
    v_exp_f32 v89, v89
    v_exp_f32 v90, v90
    v_exp_f32 v91, v91
    v_exp_f32 v60, v60
    v_exp_f32 v61, v61
    v_cvt_pk_bf16_f32 v80, v84, v85
    v_cvt_pk_bf16_f32 v81, v86, v87
    v_cvt_pk_bf16_f32 v82, v88, v89
    v_cvt_pk_bf16_f32 v83, v90, v91
    v_exp_f32 v62, v62
    v_exp_f32 v63, v63
    v_mfma_f32_32x32x16_bf16 a[240:255], v[104:107], v[80:83], a[240:255]
    buffer_load_dwordx4 v13, s[20:23], s80 offen offset:1024 lds
    v_exp_f32 v64, v64
    v_exp_f32 v65, v65
    v_exp_f32 v66, v66
    v_exp_f32 v67, v67
    s_waitcnt lgkmcnt(0)
    v_mfma_f32_32x32x16_bf16 v[76:91], v[108:111], v[40:43], 0
    ds_read_b128 v[100:103], v58 offset:35360
    ds_read_b128 v[104:107], v58 offset:36400
    buffer_load_dwordx4 v14, s[20:23], s80 offen offset:2048 lds
    buffer_load_dwordx4 v15, s[20:23], s80 offen offset:3072 lds
    ds_read_b64_tr_b16 a[0:1], v27 offset:0
    ds_read_b64_tr_b16 a[2:3], v27 offset:1024
    ds_read_b64_tr_b16 a[4:5], v48 offset:0
    ds_read_b64_tr_b16 a[6:7], v48 offset:1024
    ds_read_b64_tr_b16 a[8:9], v27 offset:2048
    ds_read_b64_tr_b16 a[10:11], v27 offset:3072
    ds_read_b64_tr_b16 a[12:13], v48 offset:2048
    ds_read_b64_tr_b16 a[14:15], v48 offset:3072
    v_exp_f32 v68, v68
    v_exp_f32 v69, v69
    v_cvt_pk_bf16_f32 v60, v60, v61
    v_cvt_pk_bf16_f32 v61, v62, v63
    v_cvt_pk_bf16_f32 v62, v64, v65
    v_cvt_pk_bf16_f32 v63, v66, v67
    v_exp_f32 v70, v70
    v_exp_f32 v71, v71
    v_mfma_f32_32x32x16_bf16 a[224:239], v[92:95], v[60:63], a[224:239]
    s_waitcnt vmcnt(12)
    s_barrier
    ds_read_b128 v[108:111], v56 offset:24960
    s_waitcnt lgkmcnt(1)
    s_add_u32 m0, s45, 0x14500
    s_add_u32 s80, s44, 0x20000
    buffer_load_dwordx4 v12, s[20:23], s80 offen lds
    v_mov_b32 v4, s58
    v_mov_b32 v5, s59
    v_mov_b32 v6, s81
    v_mov_b32 v7, 0
    buffer_store_dwordx4 v[4:7], v10, s[28:31], s46 offen sc1
    v_exp_f32 v72, v72
    v_exp_f32 v73, v73
    v_exp_f32 v74, v74
    v_exp_f32 v75, v75
    v_exp_f32 v76, v76
    v_exp_f32 v77, v77
    v_cvt_pk_bf16_f32 v64, v68, v69
    v_cvt_pk_bf16_f32 v65, v70, v71
    v_cvt_pk_bf16_f32 v66, v72, v73
    v_cvt_pk_bf16_f32 v67, v74, v75
    v_exp_f32 v78, v78
    v_exp_f32 v79, v79
    v_mfma_f32_32x32x16_bf16 a[224:239], v[96:99], v[64:67], a[224:239]
    buffer_load_dwordx4 v13, s[20:23], s80 offen offset:1024 lds
    v_exp_f32 v80, v80
    v_exp_f32 v81, v81
    v_exp_f32 v82, v82
    v_exp_f32 v83, v83
    s_waitcnt lgkmcnt(0)
    v_mfma_f32_32x32x16_bf16 v[60:75], v[108:111], v[36:39], 0
    ds_read_b128 v[92:95], v57 offset:27040
    ds_read_b128 v[96:99], v57 offset:28080
    buffer_load_dwordx4 v14, s[20:23], s80 offen offset:2048 lds
    buffer_load_dwordx4 v15, s[20:23], s80 offen offset:3072 lds
    ds_read_b64_tr_b16 a[16:17], v27 offset:4096
    ds_read_b64_tr_b16 a[18:19], v27 offset:5120
    ds_read_b64_tr_b16 a[20:21], v48 offset:4096
    ds_read_b64_tr_b16 a[22:23], v48 offset:5120
    ds_read_b64_tr_b16 a[24:25], v27 offset:6144
    ds_read_b64_tr_b16 a[26:27], v27 offset:7168
    ds_read_b64_tr_b16 a[28:29], v48 offset:6144
    ds_read_b64_tr_b16 a[30:31], v48 offset:7168
    v_exp_f32 v84, v84
    v_exp_f32 v85, v85
    v_cvt_pk_bf16_f32 v76, v76, v77
    v_cvt_pk_bf16_f32 v77, v78, v79
    v_cvt_pk_bf16_f32 v78, v80, v81
    v_cvt_pk_bf16_f32 v79, v82, v83
    v_exp_f32 v86, v86
    v_exp_f32 v87, v87
    v_mfma_f32_32x32x16_bf16 a[240:255], v[100:103], v[76:79], a[240:255]
    ds_read_b128 v[108:111], v56 offset:26000
    s_waitcnt lgkmcnt(1)
    s_add_u32 m0, s45, 0x15500
    s_add_u32 s80, s44, 0x28000
    buffer_load_dwordx4 v12, s[20:23], s80 offen lds
    v_exp_f32 v88, v88
    v_exp_f32 v89, v89
    v_exp_f32 v90, v90
    v_exp_f32 v91, v91
    v_exp_f32 v60, v60
    v_exp_f32 v61, v61
    v_cvt_pk_bf16_f32 v80, v84, v85
    v_cvt_pk_bf16_f32 v81, v86, v87
    v_cvt_pk_bf16_f32 v82, v88, v89
    v_cvt_pk_bf16_f32 v83, v90, v91
    v_exp_f32 v62, v62
    v_exp_f32 v63, v63
    v_mfma_f32_32x32x16_bf16 a[240:255], v[104:107], v[80:83], a[240:255]
    buffer_load_dwordx4 v13, s[20:23], s80 offen offset:1024 lds
    v_exp_f32 v64, v64
    v_exp_f32 v65, v65
    v_exp_f32 v66, v66
    v_exp_f32 v67, v67
    s_waitcnt lgkmcnt(0)
    v_mfma_f32_32x32x16_bf16 v[76:91], v[108:111], v[40:43], 0
    ds_read_b128 v[100:103], v58 offset:27040
    ds_read_b128 v[104:107], v58 offset:28080
    buffer_load_dwordx4 v14, s[20:23], s80 offen offset:2048 lds
    buffer_load_dwordx4 v15, s[20:23], s80 offen offset:3072 lds
    ds_read_b64_tr_b16 a[32:33], v27 offset:8192
    ds_read_b64_tr_b16 a[34:35], v27 offset:9216
    ds_read_b64_tr_b16 a[36:37], v48 offset:8192
    ds_read_b64_tr_b16 a[38:39], v48 offset:9216
    ds_read_b64_tr_b16 a[40:41], v27 offset:10240
    ds_read_b64_tr_b16 a[42:43], v27 offset:11264
    ds_read_b64_tr_b16 a[44:45], v48 offset:10240
    ds_read_b64_tr_b16 a[46:47], v48 offset:11264
    v_exp_f32 v68, v68
    v_exp_f32 v69, v69
    v_cvt_pk_bf16_f32 v60, v60, v61
    v_cvt_pk_bf16_f32 v61, v62, v63
    v_cvt_pk_bf16_f32 v62, v64, v65
    v_cvt_pk_bf16_f32 v63, v66, v67
    v_exp_f32 v70, v70
    v_exp_f32 v71, v71
    v_mfma_f32_32x32x16_bf16 a[224:239], v[92:95], v[60:63], a[224:239]
    ds_read_b128 v[108:111], v56 offset:16640
    s_waitcnt lgkmcnt(1)
    s_add_u32 m0, s45, 0x16500
    s_add_u32 s80, s44, 0x30000
    buffer_load_dwordx4 v12, s[20:23], s80 offen lds
    s_waitcnt vmcnt(14)
    buffer_store_dwordx2 v[16:17], v10, s[28:31], s5 offen sc1
    v_exp_f32 v72, v72
    v_exp_f32 v73, v73
    v_exp_f32 v74, v74
    v_exp_f32 v75, v75
    v_exp_f32 v76, v76
    v_exp_f32 v77, v77
    v_cvt_pk_bf16_f32 v64, v68, v69
    v_cvt_pk_bf16_f32 v65, v70, v71
    v_cvt_pk_bf16_f32 v66, v72, v73
    v_cvt_pk_bf16_f32 v67, v74, v75
    v_exp_f32 v78, v78
    v_exp_f32 v79, v79
    v_mfma_f32_32x32x16_bf16 a[224:239], v[96:99], v[64:67], a[224:239]
    buffer_load_dwordx4 v13, s[20:23], s80 offen offset:1024 lds
    v_exp_f32 v80, v80
    v_exp_f32 v81, v81
    v_exp_f32 v82, v82
    v_exp_f32 v83, v83
    s_waitcnt lgkmcnt(0)
    v_mfma_f32_32x32x16_bf16 v[60:75], v[108:111], v[36:39], 0
    ds_read_b128 v[92:95], v57 offset:18720
    ds_read_b128 v[96:99], v57 offset:19760
    buffer_load_dwordx4 v14, s[20:23], s80 offen offset:2048 lds
    buffer_load_dwordx4 v15, s[20:23], s80 offen offset:3072 lds
    s_waitcnt vmcnt(14)
    ds_read_b64_tr_b16 a[48:49], v27 offset:12288
    ds_read_b64_tr_b16 a[50:51], v27 offset:13312
    ds_read_b64_tr_b16 a[52:53], v48 offset:12288
    ds_read_b64_tr_b16 a[54:55], v48 offset:13312
    ds_read_b64_tr_b16 a[56:57], v27 offset:14336
    ds_read_b64_tr_b16 a[58:59], v27 offset:15360
    ds_read_b64_tr_b16 a[60:61], v48 offset:14336
    ds_read_b64_tr_b16 a[62:63], v48 offset:15360
    v_exp_f32 v84, v84
    v_exp_f32 v85, v85
    v_cvt_pk_bf16_f32 v76, v76, v77
    v_cvt_pk_bf16_f32 v77, v78, v79
    v_cvt_pk_bf16_f32 v78, v80, v81
    v_cvt_pk_bf16_f32 v79, v82, v83
    v_exp_f32 v86, v86
    v_exp_f32 v87, v87
    v_mfma_f32_32x32x16_bf16 a[240:255], v[100:103], v[76:79], a[240:255]
    ds_read_b128 v[108:111], v56 offset:17680
    s_waitcnt lgkmcnt(1)
    s_add_u32 m0, s45, 0x17500
    s_add_u32 s80, s44, 0x38000
    buffer_load_dwordx4 v12, s[20:23], s80 offen lds
    v_exp_f32 v88, v88
    v_exp_f32 v89, v89
    v_exp_f32 v90, v90
    v_exp_f32 v91, v91
    v_exp_f32 v60, v60
    v_exp_f32 v61, v61
    v_cvt_pk_bf16_f32 v80, v84, v85
    v_cvt_pk_bf16_f32 v81, v86, v87
    v_cvt_pk_bf16_f32 v82, v88, v89
    v_cvt_pk_bf16_f32 v83, v90, v91
    v_exp_f32 v62, v62
    v_exp_f32 v63, v63
    v_mfma_f32_32x32x16_bf16 a[240:255], v[104:107], v[80:83], a[240:255]
    buffer_load_dwordx4 v13, s[20:23], s80 offen offset:1024 lds
    v_exp_f32 v64, v64
    v_exp_f32 v65, v65
    v_exp_f32 v66, v66
    v_exp_f32 v67, v67
    s_waitcnt lgkmcnt(0)
    v_mfma_f32_32x32x16_bf16 v[76:91], v[108:111], v[40:43], 0
    ds_read_b128 v[100:103], v58 offset:18720
    ds_read_b128 v[104:107], v58 offset:19760
    buffer_load_dwordx4 v14, s[20:23], s80 offen offset:2048 lds
    buffer_load_dwordx4 v15, s[20:23], s80 offen offset:3072 lds
    s_waitcnt vmcnt(13)
    ds_read_b64_tr_b16 a[64:65], v27 offset:0
    ds_read_b64_tr_b16 a[66:67], v27 offset:1024
    ds_read_b64_tr_b16 a[68:69], v48 offset:0
    ds_read_b64_tr_b16 a[70:71], v48 offset:1024
    ds_read_b64_tr_b16 a[72:73], v27 offset:2048
    ds_read_b64_tr_b16 a[74:75], v27 offset:3072
    ds_read_b64_tr_b16 a[76:77], v48 offset:2048
    ds_read_b64_tr_b16 a[78:79], v48 offset:3072
    v_exp_f32 v68, v68
    v_exp_f32 v69, v69
    v_cvt_pk_bf16_f32 v60, v60, v61
    v_cvt_pk_bf16_f32 v61, v62, v63
    v_cvt_pk_bf16_f32 v62, v64, v65
    v_cvt_pk_bf16_f32 v63, v66, v67
    v_exp_f32 v70, v70
    v_exp_f32 v71, v71
    v_mfma_f32_32x32x16_bf16 a[224:239], v[92:95], v[60:63], a[224:239]
    s_barrier
    ds_read_b128 v[108:111], v56 offset:8320
    s_waitcnt lgkmcnt(1)
    s_add_u32 m0, s45, 0x14500
    s_add_u32 s80, s44, 0x40000
    buffer_load_dwordx4 v12, s[20:23], s80 offen lds
    v_exp_f32 v72, v72
    v_exp_f32 v73, v73
    v_exp_f32 v74, v74
    v_exp_f32 v75, v75
    v_exp_f32 v76, v76
    v_exp_f32 v77, v77
    v_cvt_pk_bf16_f32 v64, v68, v69
    v_cvt_pk_bf16_f32 v65, v70, v71
    v_cvt_pk_bf16_f32 v66, v72, v73
    v_cvt_pk_bf16_f32 v67, v74, v75
    v_exp_f32 v78, v78
    v_exp_f32 v79, v79
    v_mfma_f32_32x32x16_bf16 a[224:239], v[96:99], v[64:67], a[224:239]
    buffer_load_dwordx4 v13, s[20:23], s80 offen offset:1024 lds
    v_exp_f32 v80, v80
    v_exp_f32 v81, v81
    v_exp_f32 v82, v82
    v_exp_f32 v83, v83
    s_waitcnt lgkmcnt(0)
    v_mfma_f32_32x32x16_bf16 v[60:75], v[108:111], v[36:39], 0
    ds_read_b128 v[92:95], v57 offset:10400
    ds_read_b128 v[96:99], v57 offset:11440
    buffer_load_dwordx4 v14, s[20:23], s80 offen offset:2048 lds
    buffer_load_dwordx4 v15, s[20:23], s80 offen offset:3072 lds
    s_waitcnt vmcnt(13)
    ds_read_b64_tr_b16 a[80:81], v27 offset:4096
    ds_read_b64_tr_b16 a[82:83], v27 offset:5120
    ds_read_b64_tr_b16 a[84:85], v48 offset:4096
    ds_read_b64_tr_b16 a[86:87], v48 offset:5120
    ds_read_b64_tr_b16 a[88:89], v27 offset:6144
    ds_read_b64_tr_b16 a[90:91], v27 offset:7168
    ds_read_b64_tr_b16 a[92:93], v48 offset:6144
    ds_read_b64_tr_b16 a[94:95], v48 offset:7168
    v_exp_f32 v84, v84
    v_exp_f32 v85, v85
    v_cvt_pk_bf16_f32 v76, v76, v77
    v_cvt_pk_bf16_f32 v77, v78, v79
    v_cvt_pk_bf16_f32 v78, v80, v81
    v_cvt_pk_bf16_f32 v79, v82, v83
    v_exp_f32 v86, v86
    v_exp_f32 v87, v87
    v_mfma_f32_32x32x16_bf16 a[240:255], v[100:103], v[76:79], a[240:255]
    ds_read_b128 v[108:111], v56 offset:9360
    s_waitcnt lgkmcnt(1)
    s_add_u32 m0, s45, 0x15500
    s_add_u32 s80, s44, 0x48000
    buffer_load_dwordx4 v12, s[20:23], s80 offen lds
    v_exp_f32 v88, v88
    v_exp_f32 v89, v89
    v_exp_f32 v90, v90
    v_exp_f32 v91, v91
    v_exp_f32 v60, v60
    v_exp_f32 v61, v61
    v_cvt_pk_bf16_f32 v80, v84, v85
    v_cvt_pk_bf16_f32 v81, v86, v87
    v_cvt_pk_bf16_f32 v82, v88, v89
    v_cvt_pk_bf16_f32 v83, v90, v91
    v_exp_f32 v62, v62
    v_exp_f32 v63, v63
    v_mfma_f32_32x32x16_bf16 a[240:255], v[104:107], v[80:83], a[240:255]
    buffer_load_dwordx4 v13, s[20:23], s80 offen offset:1024 lds
    v_exp_f32 v64, v64
    v_exp_f32 v65, v65
    v_exp_f32 v66, v66
    v_exp_f32 v67, v67
    s_waitcnt lgkmcnt(0)
    v_mfma_f32_32x32x16_bf16 v[76:91], v[108:111], v[40:43], 0
    ds_read_b128 v[100:103], v58 offset:10400
    ds_read_b128 v[104:107], v58 offset:11440
    buffer_load_dwordx4 v14, s[20:23], s80 offen offset:2048 lds
    buffer_load_dwordx4 v15, s[20:23], s80 offen offset:3072 lds
    s_waitcnt vmcnt(12)
    ds_read_b64_tr_b16 a[96:97], v27 offset:8192
    ds_read_b64_tr_b16 a[98:99], v27 offset:9216
    ds_read_b64_tr_b16 a[100:101], v48 offset:8192
    ds_read_b64_tr_b16 a[102:103], v48 offset:9216
    ds_read_b64_tr_b16 a[104:105], v27 offset:10240
    ds_read_b64_tr_b16 a[106:107], v27 offset:11264
    ds_read_b64_tr_b16 a[108:109], v48 offset:10240
    ds_read_b64_tr_b16 a[110:111], v48 offset:11264
    v_exp_f32 v68, v68
    v_exp_f32 v69, v69
    v_cvt_pk_bf16_f32 v60, v60, v61
    v_cvt_pk_bf16_f32 v61, v62, v63
    v_cvt_pk_bf16_f32 v62, v64, v65
    v_cvt_pk_bf16_f32 v63, v66, v67
    v_exp_f32 v70, v70
    v_exp_f32 v71, v71
    v_mfma_f32_32x32x16_bf16 a[224:239], v[92:95], v[60:63], a[224:239]
    ds_read_b128 v[108:111], v56 offset:0
    s_waitcnt lgkmcnt(1)
    s_add_u32 m0, s45, 0x16500
    s_add_u32 s80, s44, 0x50000
    buffer_load_dwordx4 v12, s[20:23], s80 offen lds
    v_exp_f32 v72, v72
    v_exp_f32 v73, v73
    v_exp_f32 v74, v74
    v_exp_f32 v75, v75
    v_exp_f32 v76, v76
    v_exp_f32 v77, v77
    v_cvt_pk_bf16_f32 v64, v68, v69
    v_cvt_pk_bf16_f32 v65, v70, v71
    v_cvt_pk_bf16_f32 v66, v72, v73
    v_cvt_pk_bf16_f32 v67, v74, v75
    v_exp_f32 v78, v78
    v_exp_f32 v79, v79
    v_mfma_f32_32x32x16_bf16 a[224:239], v[96:99], v[64:67], a[224:239]
    buffer_load_dwordx4 v13, s[20:23], s80 offen offset:1024 lds
    v_exp_f32 v80, v80
    v_exp_f32 v81, v81
    v_exp_f32 v82, v82
    v_exp_f32 v83, v83
    s_waitcnt lgkmcnt(0)
    v_mfma_f32_32x32x16_bf16 v[60:75], v[108:111], v[36:39], 0
    ds_read_b128 v[92:95], v57 offset:2080
    ds_read_b128 v[96:99], v57 offset:3120
    buffer_load_dwordx4 v14, s[20:23], s80 offen offset:2048 lds
    buffer_load_dwordx4 v15, s[20:23], s80 offen offset:3072 lds
    s_waitcnt vmcnt(12)
    ds_read_b64_tr_b16 a[112:113], v27 offset:12288
    ds_read_b64_tr_b16 a[114:115], v27 offset:13312
    ds_read_b64_tr_b16 a[116:117], v48 offset:12288
    ds_read_b64_tr_b16 a[118:119], v48 offset:13312
    ds_read_b64_tr_b16 a[120:121], v27 offset:14336
    ds_read_b64_tr_b16 a[122:123], v27 offset:15360
    ds_read_b64_tr_b16 a[124:125], v48 offset:14336
    ds_read_b64_tr_b16 a[126:127], v48 offset:15360
    v_exp_f32 v84, v84
    v_exp_f32 v85, v85
    v_cvt_pk_bf16_f32 v76, v76, v77
    v_cvt_pk_bf16_f32 v77, v78, v79
    v_cvt_pk_bf16_f32 v78, v80, v81
    v_cvt_pk_bf16_f32 v79, v82, v83
    v_exp_f32 v86, v86
    v_exp_f32 v87, v87
    v_mfma_f32_32x32x16_bf16 a[240:255], v[100:103], v[76:79], a[240:255]
    ds_read_b128 v[108:111], v56 offset:1040
    s_waitcnt lgkmcnt(1)
    s_add_u32 m0, s45, 0x17500
    s_add_u32 s80, s44, 0x58000
    buffer_load_dwordx4 v12, s[20:23], s80 offen lds
    v_exp_f32 v88, v88
    v_exp_f32 v89, v89
    v_exp_f32 v90, v90
    v_exp_f32 v91, v91
    v_exp_f32 v60, v60
    v_exp_f32 v61, v61
    v_cvt_pk_bf16_f32 v80, v84, v85
    v_cvt_pk_bf16_f32 v81, v86, v87
    v_cvt_pk_bf16_f32 v82, v88, v89
    v_cvt_pk_bf16_f32 v83, v90, v91
    v_exp_f32 v62, v62
    v_exp_f32 v63, v63
    v_mfma_f32_32x32x16_bf16 a[240:255], v[104:107], v[80:83], a[240:255]
    buffer_load_dwordx4 v13, s[20:23], s80 offen offset:1024 lds
    v_exp_f32 v64, v64
    v_exp_f32 v65, v65
    v_exp_f32 v66, v66
    v_exp_f32 v67, v67
    s_waitcnt lgkmcnt(0)
    v_mfma_f32_32x32x16_bf16 v[76:91], v[108:111], v[40:43], 0
    ds_read_b128 v[100:103], v58 offset:2080
    ds_read_b128 v[104:107], v58 offset:3120
    buffer_load_dwordx4 v14, s[20:23], s80 offen offset:2048 lds
    buffer_load_dwordx4 v15, s[20:23], s80 offen offset:3072 lds
    s_waitcnt vmcnt(12)
    ds_read_b64_tr_b16 a[128:129], v27 offset:0
    ds_read_b64_tr_b16 a[130:131], v27 offset:1024
    ds_read_b64_tr_b16 a[132:133], v48 offset:0
    ds_read_b64_tr_b16 a[134:135], v48 offset:1024
    ds_read_b64_tr_b16 a[136:137], v27 offset:2048
    ds_read_b64_tr_b16 a[138:139], v27 offset:3072
    ds_read_b64_tr_b16 a[140:141], v48 offset:2048
    ds_read_b64_tr_b16 a[142:143], v48 offset:3072
    v_exp_f32 v68, v68
    v_exp_f32 v69, v69
    v_cvt_pk_bf16_f32 v60, v60, v61
    v_cvt_pk_bf16_f32 v61, v62, v63
    v_cvt_pk_bf16_f32 v62, v64, v65
    v_cvt_pk_bf16_f32 v63, v66, v67
    v_exp_f32 v70, v70
    v_exp_f32 v71, v71
    v_mfma_f32_32x32x16_bf16 a[224:239], v[92:95], v[60:63], a[224:239]
    s_barrier
    v_subrev_u32 v56, 16640, v56
    v_subrev_u32 v57, 16640, v57
    v_subrev_u32 v58, 16640, v58
    ds_read_b128 v[108:111], v56 offset:8320
    s_waitcnt lgkmcnt(1)
    s_add_u32 m0, s45, 0x14500
    s_add_u32 s80, s44, 0x60000
    buffer_load_dwordx4 v12, s[20:23], s80 offen lds
    v_exp_f32 v72, v72
    v_exp_f32 v73, v73
    v_exp_f32 v74, v74
    v_exp_f32 v75, v75
    v_exp_f32 v76, v76
    v_exp_f32 v77, v77
    v_cvt_pk_bf16_f32 v64, v68, v69
    v_cvt_pk_bf16_f32 v65, v70, v71
    v_cvt_pk_bf16_f32 v66, v72, v73
    v_cvt_pk_bf16_f32 v67, v74, v75
    v_exp_f32 v78, v78
    v_exp_f32 v79, v79
    v_mfma_f32_32x32x16_bf16 a[224:239], v[96:99], v[64:67], a[224:239]
    buffer_load_dwordx4 v13, s[20:23], s80 offen offset:1024 lds
    v_exp_f32 v80, v80
    v_exp_f32 v81, v81
    v_exp_f32 v82, v82
    v_exp_f32 v83, v83
    s_waitcnt lgkmcnt(0)
    v_mfma_f32_32x32x16_bf16 v[60:75], v[108:111], v[36:39], 0
    ds_read_b128 v[92:95], v57 offset:10400
    ds_read_b128 v[96:99], v57 offset:11440
    buffer_load_dwordx4 v14, s[20:23], s80 offen offset:2048 lds
    buffer_load_dwordx4 v15, s[20:23], s80 offen offset:3072 lds
    s_waitcnt vmcnt(12)
    ds_read_b64_tr_b16 a[144:145], v27 offset:4096
    ds_read_b64_tr_b16 a[146:147], v27 offset:5120
    ds_read_b64_tr_b16 a[148:149], v48 offset:4096
    ds_read_b64_tr_b16 a[150:151], v48 offset:5120
    ds_read_b64_tr_b16 a[152:153], v27 offset:6144
    ds_read_b64_tr_b16 a[154:155], v27 offset:7168
    ds_read_b64_tr_b16 a[156:157], v48 offset:6144
    ds_read_b64_tr_b16 a[158:159], v48 offset:7168
    v_exp_f32 v84, v84
    v_exp_f32 v85, v85
    v_cvt_pk_bf16_f32 v76, v76, v77
    v_cvt_pk_bf16_f32 v77, v78, v79
    v_cvt_pk_bf16_f32 v78, v80, v81
    v_cvt_pk_bf16_f32 v79, v82, v83
    v_exp_f32 v86, v86
    v_exp_f32 v87, v87
    v_mfma_f32_32x32x16_bf16 a[240:255], v[100:103], v[76:79], a[240:255]
    ds_read_b128 v[108:111], v56 offset:9360
    s_waitcnt lgkmcnt(1)
    s_add_u32 m0, s45, 0x15500
    s_add_u32 s80, s44, 0x68000
    buffer_load_dwordx4 v12, s[20:23], s80 offen lds
    v_exp_f32 v88, v88
    v_exp_f32 v89, v89
    v_exp_f32 v90, v90
    v_exp_f32 v91, v91
    v_exp_f32 v60, v60
    v_exp_f32 v61, v61
    v_cvt_pk_bf16_f32 v80, v84, v85
    v_cvt_pk_bf16_f32 v81, v86, v87
    v_cvt_pk_bf16_f32 v82, v88, v89
    v_cvt_pk_bf16_f32 v83, v90, v91
    v_exp_f32 v62, v62
    v_exp_f32 v63, v63
    v_mfma_f32_32x32x16_bf16 a[240:255], v[104:107], v[80:83], a[240:255]
    buffer_load_dwordx4 v13, s[20:23], s80 offen offset:1024 lds
    s_mov_b32 exec_hi, 15
    buffer_load_dwordx4 v[20:23], v55, s[28:31], 0 offen sc1
    s_mov_b32 exec_hi, -1
    v_exp_f32 v64, v64
    v_exp_f32 v65, v65
    v_exp_f32 v66, v66
    v_exp_f32 v67, v67
    s_waitcnt lgkmcnt(0)
    v_mfma_f32_32x32x16_bf16 v[76:91], v[108:111], v[40:43], 0
    ds_read_b128 v[100:103], v58 offset:10400
    ds_read_b128 v[104:107], v58 offset:11440
    buffer_load_dwordx4 v14, s[20:23], s80 offen offset:2048 lds
    buffer_load_dwordx4 v15, s[20:23], s80 offen offset:3072 lds
    s_waitcnt vmcnt(13)
    ds_read_b64_tr_b16 a[160:161], v27 offset:8192
    ds_read_b64_tr_b16 a[162:163], v27 offset:9216
    ds_read_b64_tr_b16 a[164:165], v48 offset:8192
    ds_read_b64_tr_b16 a[166:167], v48 offset:9216
    ds_read_b64_tr_b16 a[168:169], v27 offset:10240
    ds_read_b64_tr_b16 a[170:171], v27 offset:11264
    ds_read_b64_tr_b16 a[172:173], v48 offset:10240
    ds_read_b64_tr_b16 a[174:175], v48 offset:11264
    v_exp_f32 v68, v68
    v_exp_f32 v69, v69
    v_cvt_pk_bf16_f32 v60, v60, v61
    v_cvt_pk_bf16_f32 v61, v62, v63
    v_cvt_pk_bf16_f32 v62, v64, v65
    v_cvt_pk_bf16_f32 v63, v66, v67
    v_exp_f32 v70, v70
    v_exp_f32 v71, v71
    v_mfma_f32_32x32x16_bf16 a[224:239], v[92:95], v[60:63], a[224:239]
    ds_read_b128 v[108:111], v56 offset:0
    v_exp_f32 v72, v72
    v_exp_f32 v73, v73
    v_exp_f32 v74, v74
    v_exp_f32 v75, v75
    v_exp_f32 v76, v76
    v_exp_f32 v77, v77
    v_cvt_pk_bf16_f32 v64, v68, v69
    v_cvt_pk_bf16_f32 v65, v70, v71
    v_cvt_pk_bf16_f32 v66, v72, v73
    v_cvt_pk_bf16_f32 v67, v74, v75
    v_exp_f32 v78, v78
    v_exp_f32 v79, v79
    v_mfma_f32_32x32x16_bf16 a[224:239], v[96:99], v[64:67], a[224:239]
    v_exp_f32 v80, v80
    v_exp_f32 v81, v81
    v_exp_f32 v82, v82
    v_exp_f32 v83, v83
    s_waitcnt lgkmcnt(0)
    v_mfma_f32_32x32x16_bf16 v[60:75], v[108:111], v[36:39], v[152:167]
    ds_read_b128 v[92:95], v57 offset:2080
    ds_read_b128 v[96:99], v57 offset:3120
    s_mul_i32 s41, s0, 288
    v_add_u32 v4, s41, v2
    v_min_u32 v4, L_code_end-L_pc-16, v4
    s_mov_b32 m0, 156928
    s_mov_b64 exec, 0x3ffff
    global_load_lds_dwordx4 v4, s[62:63]
    s_mov_b64 exec, -1
    v_exp_f32 v84, v84
    v_exp_f32 v85, v85
    v_cvt_pk_bf16_f32 v76, v76, v77
    v_cvt_pk_bf16_f32 v77, v78, v79
    v_cvt_pk_bf16_f32 v78, v80, v81
    v_cvt_pk_bf16_f32 v79, v82, v83
    v_exp_f32 v86, v86
    v_exp_f32 v87, v87
    v_mfma_f32_32x32x16_bf16 a[240:255], v[100:103], v[76:79], a[240:255]
    ds_read_b128 v[108:111], v56 offset:1040
    v_exp_f32 v88, v88
    v_exp_f32 v89, v89
    v_exp_f32 v90, v90
    v_exp_f32 v91, v91
    v_exp_f32 v60, v60
    v_exp_f32 v61, v61
    v_cvt_pk_bf16_f32 v80, v84, v85
    v_cvt_pk_bf16_f32 v81, v86, v87
    v_cvt_pk_bf16_f32 v82, v88, v89
    v_cvt_pk_bf16_f32 v83, v90, v91
    v_exp_f32 v62, v62
    v_exp_f32 v63, v63
    v_mfma_f32_32x32x16_bf16 a[240:255], v[104:107], v[80:83], a[240:255]
    v_exp_f32 v64, v64
    v_exp_f32 v65, v65
    v_exp_f32 v66, v66
    v_exp_f32 v67, v67
    s_waitcnt lgkmcnt(0)
    v_mfma_f32_32x32x16_bf16 v[76:91], v[108:111], v[40:43], v[152:167]
    ds_read_b128 v[100:103], v58 offset:2080
    ds_read_b128 v[104:107], v58 offset:3120
    s_waitcnt vmcnt(3)
    v_cmp_ne_u64 vcc, s[58:59], v[20:21]
    s_nop 0
    s_and_b32 s69, vcc_hi, 15
    s_or_b32 s69, s69, vcc_lo
    s_cbranch_scc0 L_rspin_d
    s_mov_b32 s71, 0x40000
L_rspin_l:
    buffer_load_dwordx4 v[20:23], v55, s[28:31], 0 offen sc1
    s_waitcnt vmcnt(0)
    v_cmp_ne_u64 vcc, s[58:59], v[20:21]
    s_nop 1
    s_cbranch_vccz L_rspin_d
    s_sub_u32 s71, s71, 1
    s_cbranch_scc0 L_rspin_l
L_rspin_d:
    v_cmp_ne_u32 vcc, s81, v22
    v_lshlrev_b32 v55, 4, v11
    s_mov_b32 s82, vcc_lo
    v_lshl_add_u32 v55, v18, 11, v55
    buffer_load_dwordx4 v[152:155], v55, s[28:31], s50 offen sc1
    s_add_u32 s50, s50, 4096
    v_exp_f32 v68, v68
    v_exp_f32 v69, v69
    v_cvt_pk_bf16_f32 v60, v60, v61
    v_cvt_pk_bf16_f32 v61, v62, v63
    v_cvt_pk_bf16_f32 v62, v64, v65
    v_cvt_pk_bf16_f32 v63, v66, v67
    v_exp_f32 v70, v70
    v_exp_f32 v71, v71
    v_mfma_f32_32x32x16_bf16 a[224:239], v[92:95], v[60:63], a[224:239]
    buffer_load_dwordx4 v[156:159], v55, s[28:31], s50 offen sc1
    s_add_u32 s50, s50, 4096
    v_exp_f32 v72, v72
    v_exp_f32 v73, v73
    v_exp_f32 v74, v74
    v_exp_f32 v75, v75
    v_exp_f32 v76, v76
    v_exp_f32 v77, v77
    v_cvt_pk_bf16_f32 v64, v68, v69
    v_cvt_pk_bf16_f32 v65, v70, v71
    v_cvt_pk_bf16_f32 v66, v72, v73
    v_cvt_pk_bf16_f32 v67, v74, v75
    v_exp_f32 v78, v78
    v_exp_f32 v79, v79
    v_mfma_f32_32x32x16_bf16 a[224:239], v[96:99], v[64:67], a[224:239]
    buffer_load_dwordx4 v[160:163], v55, s[28:31], s50 offen sc1
    s_add_u32 s50, s50, 4096
    v_exp_f32 v80, v80
    v_exp_f32 v81, v81
    v_exp_f32 v82, v82
    v_exp_f32 v83, v83
    buffer_load_dwordx4 v[164:167], v55, s[28:31], s50 offen sc1
    s_add_u32 s50, s50, 4096
    v_exp_f32 v84, v84
    v_exp_f32 v85, v85
    v_cvt_pk_bf16_f32 v76, v76, v77
    v_cvt_pk_bf16_f32 v77, v78, v79
    v_cvt_pk_bf16_f32 v78, v80, v81
    v_cvt_pk_bf16_f32 v79, v82, v83
    v_exp_f32 v86, v86
    v_exp_f32 v87, v87
    s_waitcnt lgkmcnt(1)
    v_mfma_f32_32x32x16_bf16 a[240:255], v[100:103], v[76:79], a[240:255]
    v_exp_f32 v88, v88
    v_exp_f32 v89, v89
    v_exp_f32 v90, v90
    v_exp_f32 v91, v91
    v_cvt_pk_bf16_f32 v80, v84, v85
    v_cvt_pk_bf16_f32 v81, v86, v87
    v_cvt_pk_bf16_f32 v82, v88, v89
    v_cvt_pk_bf16_f32 v83, v90, v91
    s_waitcnt lgkmcnt(0)
    s_nop 0
    v_mfma_f32_32x32x16_bf16 a[240:255], v[104:107], v[80:83], a[240:255]
    v_accvgpr_read_b32 v44, a232
    s_nop 10
    v_accvgpr_read_b32 v45, a240
    v_subrev_u32 v4, 0x30800000, v44
    v_subrev_u32 v5, 0x30800000, v45
    v_max_u32 v4, v4, v5
    v_cmp_lt_u32 vcc, 0x1e000000, v4
    s_nop 0
    s_cbranch_vccnz L_softmax_max
L_softmax_join:
    v_rcp_f32 v44, v44
    v_accvgpr_read_b32 v60, a224
    v_accvgpr_read_b32 v61, a225
    v_accvgpr_read_b32 v62, a226
    v_accvgpr_read_b32 v63, a227
    v_accvgpr_read_b32 v64, a228
    v_accvgpr_read_b32 v65, a229
    v_accvgpr_read_b32 v66, a230
    v_accvgpr_read_b32 v67, a231
    v_mul_f32 v60, v44, v60
    v_mul_f32 v61, v44, v61
    v_mul_f32 v62, v44, v62
    v_mul_f32 v63, v44, v63
    v_mul_f32 v64, v44, v64
    v_mul_f32 v65, v44, v65
    v_mul_f32 v66, v44, v66
    v_mul_f32 v67, v44, v67
    v_cvt_pk_bf16_f32 v100, v60, v61
    v_cvt_pk_bf16_f32 v101, v62, v63
    v_cvt_pk_bf16_f32 v102, v64, v65
    v_cvt_pk_bf16_f32 v103, v66, v67
    s_cmp_lg_u32 s82, 0
    s_cbranch_scc1 L_wt_5
    buffer_store_dwordx4 v[100:103], v2, s[28:31], s3 offen offset:0
L_wt_5_r:
    v_rcp_f32 v45, v45
    v_accvgpr_read_b32 v60, a248
    v_accvgpr_read_b32 v61, a249
    v_accvgpr_read_b32 v62, a250
    v_accvgpr_read_b32 v63, a251
    v_accvgpr_read_b32 v64, a252
    v_accvgpr_read_b32 v65, a253
    v_accvgpr_read_b32 v66, a254
    v_accvgpr_read_b32 v67, a255
    v_mul_f32 v60, v45, v60
    v_mul_f32 v61, v45, v61
    v_mul_f32 v62, v45, v62
    v_mul_f32 v63, v45, v63
    v_mul_f32 v64, v45, v64
    v_mul_f32 v65, v45, v65
    v_mul_f32 v66, v45, v66
    v_mul_f32 v67, v45, v67
    v_cvt_pk_bf16_f32 v104, v60, v61
    v_cvt_pk_bf16_f32 v105, v62, v63
    v_cvt_pk_bf16_f32 v106, v64, v65
    v_cvt_pk_bf16_f32 v107, v66, v67
    s_cmp_lg_u32 s82, 0
    s_cbranch_scc1 L_wt_6
    buffer_store_dwordx4 v[104:107], v2, s[28:31], s3 offen offset:1024
L_wt_6_r:
    ds_read_b64_tr_b16 a[176:177], v27 offset:12288
    ds_read_b64_tr_b16 a[178:179], v27 offset:13312
    ds_read_b64_tr_b16 a[180:181], v48 offset:12288
    ds_read_b64_tr_b16 a[182:183], v48 offset:13312
    ds_read_b64_tr_b16 a[184:185], v27 offset:14336
    ds_read_b64_tr_b16 a[186:187], v27 offset:15360
    ds_read_b64_tr_b16 a[188:189], v48 offset:14336
    ds_read_b64_tr_b16 a[190:191], v48 offset:15360
    ds_read_b64_tr_b16 a[192:193], v27 offset:0
    ds_read_b64_tr_b16 a[194:195], v27 offset:1024
    ds_read_b64_tr_b16 a[196:197], v48 offset:0
    ds_read_b64_tr_b16 a[198:199], v48 offset:1024
    ds_read_b64_tr_b16 a[200:201], v27 offset:2048
    ds_read_b64_tr_b16 a[202:203], v27 offset:3072
    ds_read_b64_tr_b16 a[204:205], v48 offset:2048
    ds_read_b64_tr_b16 a[206:207], v48 offset:3072
    s_waitcnt vmcnt(7)
    ds_read_b64_tr_b16 a[208:209], v27 offset:4096
    ds_read_b64_tr_b16 a[210:211], v27 offset:5120
    ds_read_b64_tr_b16 a[212:213], v48 offset:4096
    ds_read_b64_tr_b16 a[214:215], v48 offset:5120
    ds_read_b64_tr_b16 a[216:217], v27 offset:6144
    ds_read_b64_tr_b16 a[218:219], v27 offset:7168
    ds_read_b64_tr_b16 a[220:221], v48 offset:6144
    ds_read_b64_tr_b16 a[222:223], v48 offset:7168
    s_waitcnt vmcnt(0)
    s_cmp_lg_u32 s82, 0
    s_cbranch_scc1 L_wt_7
    buffer_store_dwordx2 v[16:17], v10, s[28:31], s51 offen
L_wt_7_r:
    v_add_f32 v152, v152, v156
    v_add_f32 v160, v160, v164
    v_add_f32 v153, v153, v157
    v_add_f32 v161, v161, v165
    v_add_f32 v154, v154, v158
    v_add_f32 v162, v162, v166
    v_add_f32 v155, v155, v159
    v_add_f32 v163, v163, v167
    v_add_f32 v152, v152, v160
    v_mul_f32 v152, 0x3b000000, v152
    v_mov_b32 v156, v152
    v_add_f32 v153, v153, v161
    v_mul_f32 v153, 0x3b000000, v153
    v_mov_b32 v157, v153
    v_add_f32 v154, v154, v162
    v_mul_f32 v154, 0x3b000000, v154
    v_mov_b32 v158, v154
    v_add_f32 v155, v155, v163
    v_mul_f32 v155, 0x3b000000, v155
    v_mov_b32 v159, v155
    v_permlane32_swap_b32 v152, v156
    v_add_f32 v160, v152, v156
    v_permlane32_swap_b32 v153, v157
    v_add_f32 v161, v153, v157
    v_permlane32_swap_b32 v154, v158
    v_add_f32 v162, v154, v158
    v_permlane32_swap_b32 v155, v159
    v_add_f32 v163, v155, v159
    v_cvt_pk_bf16_f32 v152, v160, v161
    v_cvt_pk_bf16_f32 v153, v162, v163
    s_waitcnt lgkmcnt(0)
    s_barrier
    v_lshrrev_b32 v55, 2, v11
    v_lshlrev_b32 v55, 5, v55
    v_and_b32 v4, 1, v11
    v_lshl_add_u32 v55, v4, 4, v55
    v_and_b32 v4, 2, v11
    v_lshl_add_u32 v55, v4, 2, v55
    s_lshl_b32 s70, s66, 8
    s_add_u32 s70, s70, 62464
    v_add_u32 v55, s70, v55
    ds_write_b64 v55, v[152:153]
    v_mov_b32 v156, 0
    v_mov_b32 v157, 0
    v_mov_b32 v158, 0
    v_mov_b32 v159, 0
    v_lshlrev_b32 v5, 4, v11
    v_add_u32 v5, 63488, v5
    ds_write_b128 v5, v[156:159]
    v_mul_u32_u24 v4, 3584, v8
    v_add_u32 v36, v4, v9
    v_add_u32 v37, 27648, v36
    v_add_u32 v38, 55296, v36
    v_add_u32 v39, 82944, v36
    v_lshrrev_b32 v4, 2, v1
    v_mul_u32_u24 v4, 3584, v4
    v_and_b32 v26, 3, v1
    v_lshl_add_u32 v26, v26, 4, v4
    v_add_u32 v27, 56320, v26
    s_lshl_b32 s70, s68, 16
    s_add_u32 s5, s40, s70
    s_mul_i32 s77, s1, 128
    s_mul_i32 s70, s68, 64
    s_add_u32 s77, s77, s70
    s_add_u32 s77, s77, 0x1020000
    s_mov_b32 s71, 0x40000
L_poll_o_8:
    s_mov_b64 exec, 0xf
    buffer_load_dwordx4 v[20:23], v2, s[28:31], s77 offen sc1
    s_waitcnt vmcnt(0)
    v_cmp_ne_u64 vcc, s[58:59], v[20:21]
    v_cmp_ne_u64 s[60:61], s[58:59], v[22:23]
    s_mov_b64 exec, -1
    s_or_b32 s70, vcc_lo, s60
    s_cbranch_scc0 L_poll_o_8_d
    s_sub_u32 s71, s71, 1
    s_cbranch_scc0 L_poll_o_8
L_poll_o_8_d:
    s_add_u32 s7, s5, 0x0
    buffer_load_dwordx4 v[152:155], v2, s[28:31], s7 offen offset:0 sc1
    s_lshl_b32 s69, s68, 9
    s_add_u32 s69, s69, 62464
    v_lshl_add_u32 v5, v18, 4, s69
    buffer_load_dwordx4 v[156:159], v2, s[28:31], s7 offen offset:1024 sc1
    v_bfe_u32 v6, v1, 4, 1
    v_and_b32 v7, 15, v1
    v_cmp_eq_u32 vcc, v6, v7
    s_add_u32 s7, s5, 0x1000
    buffer_load_dwordx4 v[160:163], v2, s[28:31], s7 offen offset:0 sc1
    v_mov_b32 v6, 63488
    s_nop 0
    v_cndmask_b32 v80, v6, v5, vcc
    buffer_load_dwordx4 v[164:167], v2, s[28:31], s7 offen offset:1024 sc1
    v_lshlrev_b32 v40, 16, v28
    v_and_b32 v41, 0xffff0000, v28
    v_lshlrev_b32 v42, 16, v29
    s_add_u32 s7, s5, 0x4000
    buffer_load_dwordx4 v[56:59], v2, s[28:31], s7 offen offset:0 sc1
    v_and_b32 v43, 0xffff0000, v29
    v_lshlrev_b32 v44, 16, v30
    v_and_b32 v45, 0xffff0000, v30
    buffer_load_dwordx4 v[60:63], v2, s[28:31], s7 offen offset:1024 sc1
    v_lshlrev_b32 v46, 16, v31
    v_and_b32 v47, 0xffff0000, v31
    v_lshlrev_b32 v48, 16, v32
    s_add_u32 s7, s5, 0x5000
    buffer_load_dwordx4 v[64:67], v2, s[28:31], s7 offen offset:0 sc1
    v_and_b32 v49, 0xffff0000, v32
    v_lshlrev_b32 v50, 16, v33
    v_and_b32 v51, 0xffff0000, v33
    buffer_load_dwordx4 v[68:71], v2, s[28:31], s7 offen offset:1024 sc1
    v_lshlrev_b32 v52, 16, v34
    v_and_b32 v53, 0xffff0000, v34
    v_lshlrev_b32 v54, 16, v35
    s_add_u32 s7, s5, 0x8000
    buffer_load_dwordx4 v[72:75], v2, s[28:31], s7 offen offset:0 sc1
    v_and_b32 v55, 0xffff0000, v35
    s_waitcnt lgkmcnt(0)
    s_barrier
    ds_read_b128 v[28:31], v80 offset:0
    ds_read_b128 v[32:35], v80 offset:32
    s_waitcnt vmcnt(8)
    v_mfma_f32_32x32x16_bf16 v[40:55], v[112:115], v[152:155], v[40:55]
    buffer_load_dwordx4 v[76:79], v2, s[28:31], s7 offen offset:1024 sc1
    v_mfma_f32_32x32x16_bf16 a[224:239], v[116:119], v[152:155], 0
    s_lshl_b32 s69, s66, 12
    s_add_u32 s69, s69, 147456
    s_waitcnt lgkmcnt(1)
    v_mfma_f32_16x16x32_bf16 v[84:87], v[28:31], v[152:155], 0
    s_nop 0
    ds_read_b128 v[28:31], v80 offset:64
    s_waitcnt vmcnt(8)
    v_mfma_f32_32x32x16_bf16 v[40:55], v[120:123], v[156:159], v[40:55]
    s_add_u32 s7, s5, 0x9000
    buffer_load_dwordx4 v[152:155], v2, s[28:31], s7 offen offset:0 sc1
    v_mfma_f32_32x32x16_bf16 a[224:239], v[124:127], v[156:159], a[224:239]
    v_add_u32 v81, s69, v2
    v_xor_b32 v82, 0x2000, v81
    s_waitcnt lgkmcnt(1)
    v_mfma_f32_16x16x32_bf16 v[84:87], v[32:35], v[156:159], v[84:87]
    s_nop 0
    ds_read_b128 v[32:35], v80 offset:96
    s_waitcnt vmcnt(8)
    v_mfma_f32_32x32x16_bf16 v[40:55], v[128:131], v[160:163], v[40:55]
    buffer_load_dwordx4 v[156:159], v2, s[28:31], s7 offen offset:1024 sc1
    v_mfma_f32_32x32x16_bf16 a[224:239], v[132:135], v[160:163], a[224:239]
    s_lshl_b32 s69, s66, 7
    s_add_u32 s69, s69, 64000
    s_waitcnt lgkmcnt(1)
    v_mfma_f32_16x16x32_bf16 v[84:87], v[28:31], v[160:163], v[84:87]
    s_nop 0
    ds_read_b128 v[28:31], v80 offset:128
    s_waitcnt vmcnt(8)
    v_mfma_f32_32x32x16_bf16 v[40:55], v[136:139], v[164:167], v[40:55]
    s_add_u32 s7, s5, 0xc000
    buffer_load_dwordx4 v[160:163], v2, s[28:31], s7 offen offset:0 sc1
    v_mfma_f32_32x32x16_bf16 a[224:239], v[140:143], v[164:167], a[224:239]
    v_lshl_add_u32 v4, v1, 2, s69
    v_lshl_add_u32 v6, v11, 2, s69
    s_waitcnt lgkmcnt(1)
    v_mfma_f32_16x16x32_bf16 v[84:87], v[32:35], v[164:167], v[84:87]
    s_nop 0
    ds_read_b128 v[32:35], v80 offset:160
    s_waitcnt vmcnt(8)
    v_mfma_f32_32x32x16_bf16 v[40:55], v[144:147], v[56:59], v[40:55]
    buffer_load_dwordx4 v[164:167], v2, s[28:31], s7 offen offset:1024 sc1
    v_mfma_f32_32x32x16_bf16 a[224:239], v[148:151], v[56:59], a[224:239]
    v_xor_b32 v7, 256, v6
    s_lshl_b32 s43, s1, 3
    s_waitcnt lgkmcnt(1)
    v_mfma_f32_16x16x32_bf16 v[84:87], v[28:31], v[56:59], v[84:87]
    s_nop 0
    ds_read_b128 v[28:31], v80 offset:192
    s_waitcnt vmcnt(8)
    v_mfma_f32_32x32x16_bf16 v[40:55], v[168:171], v[60:63], v[40:55]
    s_add_u32 s7, s5, 0xd000
    buffer_load_dwordx4 v[56:59], v2, s[28:31], s7 offen offset:0 sc1
    v_mfma_f32_32x32x16_bf16 a[224:239], v[172:175], v[60:63], a[224:239]
    s_add_u32 s43, s43, s65
    s_lshl_b32 s43, s43, 1
    s_waitcnt lgkmcnt(1)
    v_mfma_f32_16x16x32_bf16 v[84:87], v[32:35], v[60:63], v[84:87]
    s_nop 0
    ds_read_b128 v[32:35], v80 offset:224
    s_waitcnt vmcnt(8)
    v_mfma_f32_32x32x16_bf16 v[40:55], v[176:179], v[64:67], v[40:55]
    buffer_load_dwordx4 v[60:63], v2, s[28:31], s7 offen offset:1024 sc1
    v_mfma_f32_32x32x16_bf16 a[224:239], v[180:183], v[64:67], a[224:239]
    s_add_u32 s43, s43, s68
    s_lshl_b32 s43, s43, 7
    s_waitcnt lgkmcnt(1)
    v_mfma_f32_16x16x32_bf16 v[84:87], v[28:31], v[64:67], v[84:87]
    s_nop 0
    ds_read_b128 v[28:31], v80 offset:256
    s_waitcnt vmcnt(8)
    v_mfma_f32_32x32x16_bf16 v[40:55], v[184:187], v[68:71], v[40:55]
    s_add_u32 m0, s53, 0x0
    s_add_u32 s80, s52, 0x0
    buffer_load_dwordx4 v36, s[16:19], s80 offen lds
    v_mfma_f32_32x32x16_bf16 a[224:239], v[188:191], v[68:71], a[224:239]
    buffer_load_dwordx4 v37, s[16:19], s80 offen offset:1024 lds
    s_add_u32 s43, s43, 0xf00000
    s_mul_i32 s77, s1, 128
    s_mul_i32 s70, s65, 16
    s_add_u32 s77, s77, s70
    s_mul_i32 s70, s68, 8
    s_add_u32 s77, s77, s70
    s_add_u32 s77, s77, 0x1022000
    s_waitcnt lgkmcnt(1)
    v_mfma_f32_16x16x32_bf16 v[84:87], v[32:35], v[68:71], v[84:87]
    s_nop 0
    ds_read_b128 v[32:35], v80 offset:288
    s_waitcnt vmcnt(9)
    v_mfma_f32_32x32x16_bf16 v[40:55], v[192:195], v[72:75], v[40:55]
    buffer_load_dwordx4 v38, s[16:19], s80 offen offset:2048 lds
    v_mfma_f32_32x32x16_bf16 a[224:239], v[196:199], v[72:75], a[224:239]
    buffer_load_dwordx4 v39, s[16:19], s80 offen offset:3072 lds
    s_waitcnt lgkmcnt(1)
    v_mfma_f32_16x16x32_bf16 v[84:87], v[28:31], v[72:75], v[84:87]
    s_nop 0
    ds_read_b128 v[28:31], v80 offset:320
    s_waitcnt vmcnt(10)
    v_mfma_f32_32x32x16_bf16 v[40:55], v[200:203], v[76:79], v[40:55]
    s_add_u32 m0, s53, 0x18000
    s_add_u32 s80, s52, 0x80
    buffer_load_dwordx4 v36, s[16:19], s80 offen lds
    v_mfma_f32_32x32x16_bf16 a[224:239], v[204:207], v[76:79], a[224:239]
    buffer_load_dwordx4 v37, s[16:19], s80 offen offset:1024 lds
    s_waitcnt lgkmcnt(1)
    v_mfma_f32_16x16x32_bf16 v[84:87], v[32:35], v[76:79], v[84:87]
    s_nop 0
    ds_read_b128 v[32:35], v80 offset:352
    s_waitcnt vmcnt(11)
    v_mfma_f32_32x32x16_bf16 v[40:55], v[208:211], v[152:155], v[40:55]
    buffer_load_dwordx4 v38, s[16:19], s80 offen offset:2048 lds
    v_mfma_f32_32x32x16_bf16 a[224:239], v[212:215], v[152:155], a[224:239]
    buffer_load_dwordx4 v39, s[16:19], s80 offen offset:3072 lds
    s_waitcnt lgkmcnt(1)
    v_mfma_f32_16x16x32_bf16 v[84:87], v[28:31], v[152:155], v[84:87]
    s_nop 0
    ds_read_b128 v[28:31], v80 offset:384
    s_waitcnt vmcnt(12)
    v_mfma_f32_32x32x16_bf16 v[40:55], v[216:219], v[156:159], v[40:55]
    s_add_u32 m0, s55, 0x10000
    s_add_u32 s80, s54, 0x180
    buffer_load_dwordx4 v26, s[16:19], s80 offen lds
    v_mfma_f32_32x32x16_bf16 a[224:239], v[220:223], v[156:159], a[224:239]
    buffer_load_dwordx4 v27, s[16:19], s80 offen offset:1024 lds
    s_waitcnt lgkmcnt(1)
    v_mfma_f32_16x16x32_bf16 v[84:87], v[32:35], v[156:159], v[84:87]
    s_nop 0
    ds_read_b128 v[32:35], v80 offset:416
    s_waitcnt vmcnt(13)
    v_mfma_f32_32x32x16_bf16 v[40:55], v[224:227], v[160:163], v[40:55]
    s_add_u32 m0, s53, 0x4000
    s_add_u32 s80, s52, 0x70000
    buffer_load_dwordx4 v36, s[16:19], s80 offen lds
    v_mfma_f32_32x32x16_bf16 a[224:239], v[228:231], v[160:163], a[224:239]
    buffer_load_dwordx4 v37, s[16:19], s80 offen offset:1024 lds
    s_waitcnt lgkmcnt(1)
    v_mfma_f32_16x16x32_bf16 v[84:87], v[28:31], v[160:163], v[84:87]
    s_nop 0
    ds_read_b128 v[28:31], v80 offset:448
    buffer_load_dwordx4 v38, s[16:19], s80 offen offset:2048 lds
    s_waitcnt vmcnt(15)
    v_mfma_f32_32x32x16_bf16 a[224:239], v[236:239], v[164:167], a[224:239]
    buffer_load_dwordx4 v39, s[16:19], s80 offen offset:3072 lds
    s_waitcnt lgkmcnt(1)
    v_mfma_f32_16x16x32_bf16 v[84:87], v[32:35], v[164:167], v[84:87]
    s_nop 0
    ds_read_b128 v[32:35], v80 offset:480
    s_add_u32 m0, s53, 0x1c000
    s_add_u32 s80, s52, 0x70080
    buffer_load_dwordx4 v36, s[16:19], s80 offen lds
    s_waitcnt vmcnt(16)
    v_mfma_f32_32x32x16_bf16 a[224:239], v[244:247], v[56:59], a[224:239]
    buffer_load_dwordx4 v37, s[16:19], s80 offen offset:1024 lds
    s_waitcnt lgkmcnt(1)
    v_mfma_f32_16x16x32_bf16 v[84:87], v[28:31], v[56:59], v[84:87]
    buffer_load_dwordx4 v38, s[16:19], s80 offen offset:2048 lds
    s_waitcnt vmcnt(17)
    v_mfma_f32_32x32x16_bf16 a[224:239], v[252:255], v[60:63], a[224:239]
    buffer_load_dwordx4 v39, s[16:19], s80 offen offset:3072 lds
    s_waitcnt lgkmcnt(0)
    v_mfma_f32_16x16x32_bf16 v[84:87], v[32:35], v[60:63], v[84:87]
    v_mfma_f32_32x32x16_bf16 v[40:55], v[232:235], v[164:167], v[40:55]
    v_mfma_f32_32x32x16_bf16 v[40:55], v[240:243], v[56:59], v[40:55]
    s_nop 6
    ds_write_b128 v81, a[224:227] offset:0
    ds_write_b128 v81, a[228:231] offset:1024
    v_mfma_f32_32x32x16_bf16 v[40:55], v[248:251], v[60:63], v[40:55]
    ds_write_b128 v81, a[232:235] offset:2048
    ds_write_b128 v81, a[236:239] offset:3072
    s_mov_b64 exec, 0xffff
    ds_write_b32 v4, v84
    ds_write_b32 v4, v85 offset:64
    s_mov_b64 exec, -1
    s_add_u32 m0, s55, 0x12000
    s_add_u32 s80, s54, 0x70180
    buffer_load_dwordx4 v26, s[16:19], s80 offen lds
    buffer_load_dwordx4 v27, s[16:19], s80 offen offset:1024 lds
    s_add_u32 m0, s53, 0x8000
    s_add_u32 s80, s52, 0xe0000
    buffer_load_dwordx4 v36, s[16:19], s80 offen lds
    s_waitcnt lgkmcnt(0)
    s_barrier
    ds_read_b32 v84, v6
    ds_read_b32 v85, v7
    ds_read_b128 v[88:91], v82 offset:0
    ds_read_b128 v[92:95], v82 offset:1024
    ds_read_b128 v[96:99], v82 offset:2048
    ds_read_b128 v[100:103], v82 offset:3072
    s_waitcnt lgkmcnt(5)
    v_add_f32 v84, v84, v25
    s_waitcnt lgkmcnt(4)
    v_add_f32 v84, v84, v85
    s_waitcnt lgkmcnt(3)
    v_pk_add_f32 v[40:41], v[40:41], v[88:89]
    v_pk_add_f32 v[42:43], v[42:43], v[90:91]
    s_waitcnt lgkmcnt(2)
    v_pk_add_f32 v[44:45], v[44:45], v[92:93]
    v_pk_add_f32 v[46:47], v[46:47], v[94:95]
    s_waitcnt lgkmcnt(1)
    v_pk_add_f32 v[48:49], v[48:49], v[96:97]
    v_pk_add_f32 v[50:51], v[50:51], v[98:99]
    s_waitcnt lgkmcnt(0)
    v_pk_add_f32 v[52:53], v[52:53], v[100:101]
    v_pk_add_f32 v[54:55], v[54:55], v[102:103]
    v_pk_add_f32 v[88:89], v[40:41], v[84:85] op_sel_hi:[1,0] neg_lo:[0,1] neg_hi:[0,1]
    v_pk_add_f32 v[90:91], v[42:43], v[84:85] op_sel_hi:[1,0] neg_lo:[0,1] neg_hi:[0,1]
    v_pk_add_f32 v[92:93], v[44:45], v[84:85] op_sel_hi:[1,0] neg_lo:[0,1] neg_hi:[0,1]
    v_pk_add_f32 v[94:95], v[46:47], v[84:85] op_sel_hi:[1,0] neg_lo:[0,1] neg_hi:[0,1]
    v_pk_add_f32 v[96:97], v[48:49], v[84:85] op_sel_hi:[1,0] neg_lo:[0,1] neg_hi:[0,1]
    v_pk_add_f32 v[98:99], v[50:51], v[84:85] op_sel_hi:[1,0] neg_lo:[0,1] neg_hi:[0,1]
    v_pk_add_f32 v[100:101], v[52:53], v[84:85] op_sel_hi:[1,0] neg_lo:[0,1] neg_hi:[0,1]
    v_pk_add_f32 v[102:103], v[54:55], v[84:85] op_sel_hi:[1,0] neg_lo:[0,1] neg_hi:[0,1]
    v_cvt_pk_bf16_f32 v152, v88, v89
    v_cvt_pk_bf16_f32 v153, v90, v91
    v_cvt_pk_bf16_f32 v154, v92, v93
    v_cvt_pk_bf16_f32 v155, v94, v95
    s_cmp_lg_u32 s82, 0
    s_cbranch_scc1 L_wt_9
    buffer_store_dwordx4 v[152:155], v2, s[28:31], s3 offen offset:2048
L_wt_9_r:
    v_cvt_pk_bf16_f32 v156, v96, v97
    v_cvt_pk_bf16_f32 v157, v98, v99
    v_cvt_pk_bf16_f32 v158, v100, v101
    v_cvt_pk_bf16_f32 v159, v102, v103
    s_cmp_lg_u32 s82, 0
    s_cbranch_scc1 L_wt_10
    buffer_store_dwordx4 v[156:159], v2, s[28:31], s3 offen offset:3072
L_wt_10_r:
    v_pk_mul_f32 v[4:5], v[88:89], v[88:89]
    v_pk_fma_f32 v[4:5], v[90:91], v[90:91], v[4:5]
    v_pk_fma_f32 v[4:5], v[92:93], v[92:93], v[4:5]
    v_pk_fma_f32 v[4:5], v[94:95], v[94:95], v[4:5]
    v_pk_fma_f32 v[4:5], v[96:97], v[96:97], v[4:5]
    v_pk_fma_f32 v[4:5], v[98:99], v[98:99], v[4:5]
    v_pk_fma_f32 v[4:5], v[100:101], v[100:101], v[4:5]
    v_pk_fma_f32 v[4:5], v[102:103], v[102:103], v[4:5]
    v_lshlrev_b32 v7, 2, v11
    s_nop 0
    v_permlane32_swap_b32 v4, v5
    v_add_f32 v6, v4, v5
    v_mov_b32 v4, v6
    s_nop 1
    v_permlane32_swap_b32 v4, v6
    v_add_f32 v5, v4, v6
    s_cmp_lg_u32 s82, 0
    s_cbranch_scc1 L_wt_11
    buffer_store_dword v5, v7, s[28:31], s43 offen
L_wt_11_r:
    v_cvt_pk_bf16_f32 v28, v40, v41
    v_cvt_pk_bf16_f32 v29, v42, v43
    v_cvt_pk_bf16_f32 v30, v44, v45
    v_cvt_pk_bf16_f32 v31, v46, v47
    v_cvt_pk_bf16_f32 v32, v48, v49
    v_cvt_pk_bf16_f32 v33, v50, v51
    v_cvt_pk_bf16_f32 v34, v52, v53
    v_cvt_pk_bf16_f32 v35, v54, v55
    s_waitcnt vmcnt(0)
    s_cmp_lg_u32 s82, 0
    s_cbranch_scc1 L_wt_12
    buffer_store_dwordx2 v[16:17], v10, s[28:31], s77 offen
L_wt_12_r:
    v_xor_b32 v4, s68, v24
    v_lshl_add_u32 v250, v4, 6, v19
    v_mul_u32_u24 v4, 512, v18
    v_add_u32 v250, v250, v4
    v_add_u32 v251, 98304, v250
    v_bfe_u32 v4, v1, 2, 2
    v_lshl_add_u32 v4, v18, 2, v4
    v_and_b32 v5, 63, v19
    v_lshl_add_u32 v252, v4, 6, v5
    s_lshl_b32 s69, s68, 5
    v_xor_b32 v252, s69, v252
    v_add_u32 v252, 65536, v252
    s_lshl_b32 s78, s1, 11
    s_add_u32 s78, s78, 0xf00000
    v_and_b32 v4, 1, v11
    v_lshlrev_b32 v253, 7, v4
    v_and_b32 v4, 2, v11
    v_lshl_add_u32 v253, v4, 5, v253
    v_and_b32 v4, 28, v11
    v_add_u32 v253, v253, v4
    s_mul_i32 s44, s64, 256
    s_mul_i32 s70, s65, 32
    s_add_u32 s44, s44, s70
    s_mul_i32 s70, s66, 8
    s_add_u32 s44, s44, s70
    s_add_u32 s44, s44, 0x1024000
    s_mul_i32 s43, s64, 256
    s_mul_i32 s70, s66, 64
    s_add_u32 s43, s43, s70
    s_add_u32 s43, s43, 0x1024000
    s_mul_i32 s77, s1, 128
    s_add_u32 s77, s77, 0x1022000
    s_lshl_b32 s69, s68, 15
    s_add_u32 s45, s40, s69
    s_add_u32 s45, s45, 0x10000
    s_mul_i32 s70, s67, 98304
    s_add_u32 s70, s70, 49152
    v_add_u32 v254, s70, v2
    s_lshl_b32 s69, s68, 13
    s_add_u32 s46, s70, s69
    s_sub_u32 s46, s46, 2048
    s_xor_b32 s69, s40, 0x0
    s_lshl_b32 s70, s66, 15
    s_add_u32 s47, s69, s70
    s_xor_b32 s69, s40, 0x2000
    s_lshl_b32 s70, s66, 15
    s_add_u32 s48, s69, s70
    s_mov_b32 s71, 0x40000
L_poll_h_13:
    s_mov_b64 exec, 0xff
    buffer_load_dwordx4 v[20:23], v2, s[28:31], s77 offen sc1
    s_waitcnt vmcnt(0)
    v_cmp_ne_u64 vcc, s[58:59], v[20:21]
    v_cmp_ne_u64 s[60:61], s[58:59], v[22:23]
    s_mov_b64 exec, -1
    s_or_b32 s70, vcc_lo, s60
    s_cbranch_scc0 L_poll_h_13_d
    s_sub_u32 s71, s71, 1
    s_cbranch_scc0 L_poll_h_13
L_poll_h_13_d:
    s_barrier
    s_xor_b32 s7, s40, 0x0
    buffer_load_dwordx4 v[152:155], v2, s[28:31], s7 offen offset:2048
    buffer_load_dwordx4 v[156:159], v2, s[28:31], s7 offen offset:3072
    s_xor_b32 s7, s40, 0x1000
    buffer_load_dwordx4 v[160:163], v2, s[28:31], s7 offen offset:2048
    buffer_load_dwordx4 v[164:167], v2, s[28:31], s7 offen offset:3072
    ds_read_b64_tr_b16 v[120:121], v250 offset:0
    ds_read_b64_tr_b16 v[122:123], v250 offset:1024
    ds_read_b64_tr_b16 v[124:125], v251 offset:0
    ds_read_b64_tr_b16 v[126:127], v251 offset:1024
    ds_read_b64_tr_b16 v[128:129], v252 offset:0
    ds_read_b64_tr_b16 v[130:131], v252 offset:512
    ds_read_b64_tr_b16 v[132:133], v250 offset:2048
    ds_read_b64_tr_b16 v[134:135], v250 offset:3072
    ds_read_b64_tr_b16 v[136:137], v251 offset:2048
    ds_read_b64_tr_b16 v[138:139], v251 offset:3072
    ds_read_b64_tr_b16 v[140:141], v252 offset:1024
    ds_read_b64_tr_b16 v[142:143], v252 offset:1536
    s_xor_b32 s7, s40, 0x4000
    buffer_load_dwordx4 v[168:171], v2, s[28:31], s7 offen offset:2048
    buffer_load_dwordx4 v[172:175], v2, s[28:31], s7 offen offset:3072
    s_xor_b32 s7, s40, 0x5000
    buffer_load_dwordx4 v[176:179], v2, s[28:31], s7 offen offset:2048
    buffer_load_dwordx4 v[180:183], v2, s[28:31], s7 offen offset:3072
    s_xor_b32 s7, s40, 0x8000
    buffer_load_dwordx4 v[184:187], v2, s[28:31], s7 offen offset:2048
    buffer_load_dwordx4 v[188:191], v2, s[28:31], s7 offen offset:3072
    s_xor_b32 s7, s40, 0x9000
    buffer_load_dwordx4 v[192:195], v2, s[28:31], s7 offen offset:2048
    buffer_load_dwordx4 v[196:199], v2, s[28:31], s7 offen offset:3072
    s_waitcnt vmcnt(11) lgkmcnt(8)
    v_mfma_f32_32x32x16_bf16 v[40:55], v[120:123], v[152:155], 0
    ds_read_b64_tr_b16 v[144:145], v250 offset:4096
    ds_read_b64_tr_b16 v[146:147], v250 offset:5120
    v_mfma_f32_32x32x16_bf16 v[56:71], v[124:127], v[152:155], 0
    ds_read_b64_tr_b16 v[148:149], v251 offset:4096
    ds_read_b64_tr_b16 v[150:151], v251 offset:5120
    s_xor_b32 s7, s40, 0xc000
    buffer_load_dwordx4 v[200:203], v2, s[28:31], s7 offen offset:2048
    s_waitcnt lgkmcnt(10)
    v_mfma_f32_32x32x16_bf16 v[88:103], v[128:131], v[152:155], 0
    ds_read_b64_tr_b16 v[120:121], v252 offset:2048
    ds_read_b64_tr_b16 v[122:123], v252 offset:2560
    s_waitcnt vmcnt(11) lgkmcnt(8)
    v_mfma_f32_32x32x16_bf16 v[40:55], v[132:135], v[156:159], v[40:55]
    ds_read_b64_tr_b16 v[124:125], v250 offset:6144
    ds_read_b64_tr_b16 v[126:127], v250 offset:7168
    buffer_load_dwordx4 v[204:207], v2, s[28:31], s7 offen offset:3072
    v_mfma_f32_32x32x16_bf16 v[56:71], v[136:139], v[156:159], v[56:71]
    ds_read_b64_tr_b16 v[128:129], v251 offset:6144
    ds_read_b64_tr_b16 v[130:131], v251 offset:7168
    buffer_load_dwordx4 v37, s[16:19], s80 offen offset:1024 lds
    s_waitcnt lgkmcnt(10)
    v_mfma_f32_32x32x16_bf16 v[88:103], v[140:143], v[156:159], v[88:103]
    ds_read_b64_tr_b16 v[132:133], v252 offset:3072
    ds_read_b64_tr_b16 v[134:135], v252 offset:3584
    buffer_load_dwordx4 v38, s[16:19], s80 offen offset:2048 lds
    s_waitcnt vmcnt(13) lgkmcnt(8)
    v_mfma_f32_32x32x16_bf16 v[40:55], v[144:147], v[160:163], v[40:55]
    ds_read_b64_tr_b16 v[136:137], v250 offset:8192
    ds_read_b64_tr_b16 v[138:139], v250 offset:9216
    v_mfma_f32_32x32x16_bf16 v[56:71], v[148:151], v[160:163], v[56:71]
    ds_read_b64_tr_b16 v[140:141], v251 offset:8192
    ds_read_b64_tr_b16 v[142:143], v251 offset:9216
    buffer_load_dwordx4 v39, s[16:19], s80 offen offset:3072 lds
    s_waitcnt lgkmcnt(10)
    v_mfma_f32_32x32x16_bf16 v[88:103], v[120:123], v[160:163], v[88:103]
    ds_read_b64_tr_b16 v[144:145], v252 offset:4096
    ds_read_b64_tr_b16 v[146:147], v252 offset:4608
    s_waitcnt vmcnt(13) lgkmcnt(8)
    v_mfma_f32_32x32x16_bf16 v[40:55], v[124:127], v[164:167], v[40:55]
    ds_read_b64_tr_b16 v[148:149], v250 offset:10240
    ds_read_b64_tr_b16 v[150:151], v250 offset:11264
    s_add_u32 m0, s53, 0x20000
    s_add_u32 s80, s52, 0xe0080
    buffer_load_dwordx4 v36, s[16:19], s80 offen lds
    v_mfma_f32_32x32x16_bf16 v[56:71], v[128:131], v[164:167], v[56:71]
    ds_read_b64_tr_b16 v[120:121], v251 offset:10240
    ds_read_b64_tr_b16 v[122:123], v251 offset:11264
    buffer_load_dwordx4 v37, s[16:19], s80 offen offset:1024 lds
    s_waitcnt lgkmcnt(10)
    v_mfma_f32_32x32x16_bf16 v[88:103], v[132:135], v[164:167], v[88:103]
    ds_read_b64_tr_b16 v[124:125], v252 offset:5120
    ds_read_b64_tr_b16 v[126:127], v252 offset:5632
    buffer_load_dwordx4 v38, s[16:19], s80 offen offset:2048 lds
    s_waitcnt vmcnt(15) lgkmcnt(8)
    v_mfma_f32_32x32x16_bf16 v[40:55], v[136:139], v[168:171], v[40:55]
    ds_read_b64_tr_b16 v[128:129], v250 offset:12288
    ds_read_b64_tr_b16 v[130:131], v250 offset:13312
    v_mfma_f32_32x32x16_bf16 v[56:71], v[140:143], v[168:171], v[56:71]
    ds_read_b64_tr_b16 v[132:133], v251 offset:12288
    ds_read_b64_tr_b16 v[134:135], v251 offset:13312
    buffer_load_dwordx4 v39, s[16:19], s80 offen offset:3072 lds
    s_waitcnt lgkmcnt(10)
    v_mfma_f32_32x32x16_bf16 v[88:103], v[144:147], v[168:171], v[88:103]
    ds_read_b64_tr_b16 v[136:137], v252 offset:6144
    ds_read_b64_tr_b16 v[138:139], v252 offset:6656
    s_waitcnt vmcnt(15) lgkmcnt(8)
    v_mfma_f32_32x32x16_bf16 v[40:55], v[148:151], v[172:175], v[40:55]
    ds_read_b64_tr_b16 v[140:141], v250 offset:14336
    ds_read_b64_tr_b16 v[142:143], v250 offset:15360
    s_add_u32 m0, s55, 0x14000
    s_add_u32 s80, s54, 0xe0180
    buffer_load_dwordx4 v26, s[16:19], s80 offen lds
    v_mfma_f32_32x32x16_bf16 v[56:71], v[120:123], v[172:175], v[56:71]
    ds_read_b64_tr_b16 v[144:145], v251 offset:14336
    ds_read_b64_tr_b16 v[146:147], v251 offset:15360
    buffer_load_dwordx4 v27, s[16:19], s80 offen offset:1024 lds
    s_waitcnt lgkmcnt(10)
    v_mfma_f32_32x32x16_bf16 v[88:103], v[124:127], v[172:175], v[88:103]
    ds_read_b64_tr_b16 v[148:149], v252 offset:7168
    ds_read_b64_tr_b16 v[150:151], v252 offset:7680
    s_add_u32 m0, s55, 0x16000
    s_add_u32 s80, s54, 0x150180
    buffer_load_dwordx4 v26, s[16:19], s80 offen lds
    s_waitcnt vmcnt(17) lgkmcnt(8)
    v_mfma_f32_32x32x16_bf16 v[40:55], v[128:131], v[176:179], v[40:55]
    ds_read_b64_tr_b16 v[120:121], v250 offset:16384
    ds_read_b64_tr_b16 v[122:123], v250 offset:17408
    v_mfma_f32_32x32x16_bf16 v[56:71], v[132:135], v[176:179], v[56:71]
    ds_read_b64_tr_b16 v[124:125], v251 offset:16384
    ds_read_b64_tr_b16 v[126:127], v251 offset:17408
    buffer_load_dwordx4 v27, s[16:19], s80 offen offset:1024 lds
    s_waitcnt lgkmcnt(10)
    v_mfma_f32_32x32x16_bf16 v[88:103], v[136:139], v[176:179], v[88:103]
    ds_read_b64_tr_b16 v[128:129], v252 offset:8192
    ds_read_b64_tr_b16 v[130:131], v252 offset:8704
    s_waitcnt vmcnt(17) lgkmcnt(8)
    v_mfma_f32_32x32x16_bf16 v[40:55], v[140:143], v[180:183], v[40:55]
    ds_read_b64_tr_b16 v[132:133], v250 offset:18432
    ds_read_b64_tr_b16 v[134:135], v250 offset:19456
    s_xor_b32 s7, s40, 0xd000
    buffer_load_dwordx4 v[208:211], v2, s[28:31], s7 offen offset:2048
    v_mfma_f32_32x32x16_bf16 v[56:71], v[144:147], v[180:183], v[56:71]
    ds_read_b64_tr_b16 v[136:137], v251 offset:18432
    ds_read_b64_tr_b16 v[138:139], v251 offset:19456
    buffer_load_dwordx4 v[212:215], v2, s[28:31], s7 offen offset:3072
    s_waitcnt lgkmcnt(10)
    v_mfma_f32_32x32x16_bf16 v[88:103], v[148:151], v[180:183], v[88:103]
    ds_read_b64_tr_b16 v[140:141], v252 offset:9216
    ds_read_b64_tr_b16 v[142:143], v252 offset:9728
    s_xor_b32 s7, s40, 0x10000
    buffer_load_dwordx4 v[216:219], v2, s[28:31], s7 offen offset:2048
    s_waitcnt vmcnt(19) lgkmcnt(8)
    v_mfma_f32_32x32x16_bf16 v[40:55], v[120:123], v[184:187], v[40:55]
    ds_read_b64_tr_b16 v[144:145], v250 offset:20480
    ds_read_b64_tr_b16 v[146:147], v250 offset:21504
    v_mfma_f32_32x32x16_bf16 v[56:71], v[124:127], v[184:187], v[56:71]
    ds_read_b64_tr_b16 v[148:149], v251 offset:20480
    ds_read_b64_tr_b16 v[150:151], v251 offset:21504
    buffer_load_dwordx4 v[220:223], v2, s[28:31], s7 offen offset:3072
    s_waitcnt lgkmcnt(10)
    v_mfma_f32_32x32x16_bf16 v[88:103], v[128:131], v[184:187], v[88:103]
    ds_read_b64_tr_b16 v[120:121], v252 offset:10240
    ds_read_b64_tr_b16 v[122:123], v252 offset:10752
    s_waitcnt vmcnt(19) lgkmcnt(8)
    v_mfma_f32_32x32x16_bf16 v[40:55], v[132:135], v[188:191], v[40:55]
    ds_read_b64_tr_b16 v[124:125], v250 offset:22528
    ds_read_b64_tr_b16 v[126:127], v250 offset:23552
    s_xor_b32 s7, s40, 0x11000
    buffer_load_dwordx4 v[224:227], v2, s[28:31], s7 offen offset:2048
    v_mfma_f32_32x32x16_bf16 v[56:71], v[136:139], v[188:191], v[56:71]
    ds_read_b64_tr_b16 v[128:129], v251 offset:22528
    ds_read_b64_tr_b16 v[130:131], v251 offset:23552
    buffer_load_dwordx4 v[228:231], v2, s[28:31], s7 offen offset:3072
    s_waitcnt lgkmcnt(10)
    v_mfma_f32_32x32x16_bf16 v[88:103], v[140:143], v[188:191], v[88:103]
    ds_read_b64_tr_b16 v[132:133], v252 offset:11264
    ds_read_b64_tr_b16 v[134:135], v252 offset:11776
    s_xor_b32 s7, s40, 0x14000
    buffer_load_dwordx4 v[232:235], v2, s[28:31], s7 offen offset:2048
    s_waitcnt vmcnt(21) lgkmcnt(8)
    v_mfma_f32_32x32x16_bf16 v[40:55], v[144:147], v[192:195], v[40:55]
    ds_read_b64_tr_b16 v[136:137], v250 offset:24576
    ds_read_b64_tr_b16 v[138:139], v250 offset:25600
    v_mfma_f32_32x32x16_bf16 v[56:71], v[148:151], v[192:195], v[56:71]
    ds_read_b64_tr_b16 v[140:141], v251 offset:24576
    ds_read_b64_tr_b16 v[142:143], v251 offset:25600
    buffer_load_dwordx4 v[236:239], v2, s[28:31], s7 offen offset:3072
    s_waitcnt lgkmcnt(10)
    v_mfma_f32_32x32x16_bf16 v[88:103], v[120:123], v[192:195], v[88:103]
    ds_read_b64_tr_b16 v[144:145], v252 offset:12288
    ds_read_b64_tr_b16 v[146:147], v252 offset:12800
    s_waitcnt vmcnt(21) lgkmcnt(8)
    v_mfma_f32_32x32x16_bf16 v[40:55], v[124:127], v[196:199], v[40:55]
    ds_read_b64_tr_b16 v[148:149], v250 offset:26624
    ds_read_b64_tr_b16 v[150:151], v250 offset:27648
    s_add_u32 m0, s53, 0xc000
    s_add_u32 s80, s52, 0x150000
    buffer_load_dwordx4 v36, s[16:19], s80 offen lds
    v_mfma_f32_32x32x16_bf16 v[56:71], v[128:131], v[196:199], v[56:71]
    ds_read_b64_tr_b16 v[120:121], v251 offset:26624
    ds_read_b64_tr_b16 v[122:123], v251 offset:27648
    buffer_load_dwordx4 v37, s[16:19], s80 offen offset:1024 lds
    s_waitcnt lgkmcnt(10)
    v_mfma_f32_32x32x16_bf16 v[88:103], v[132:135], v[196:199], v[88:103]
    ds_read_b64_tr_b16 v[124:125], v252 offset:13312
    ds_read_b64_tr_b16 v[126:127], v252 offset:13824
    buffer_load_dwordx4 v38, s[16:19], s80 offen offset:2048 lds
    s_waitcnt vmcnt(23) lgkmcnt(8)
    v_mfma_f32_32x32x16_bf16 v[40:55], v[136:139], v[200:203], v[40:55]
    ds_read_b64_tr_b16 v[128:129], v250 offset:28672
    ds_read_b64_tr_b16 v[130:131], v250 offset:29696
    v_mfma_f32_32x32x16_bf16 v[56:71], v[140:143], v[200:203], v[56:71]
    ds_read_b64_tr_b16 v[132:133], v251 offset:28672
    ds_read_b64_tr_b16 v[134:135], v251 offset:29696
    buffer_load_dwordx4 v39, s[16:19], s80 offen offset:3072 lds
    s_waitcnt lgkmcnt(10)
    v_mfma_f32_32x32x16_bf16 v[88:103], v[144:147], v[200:203], v[88:103]
    ds_read_b64_tr_b16 v[136:137], v252 offset:14336
    ds_read_b64_tr_b16 v[138:139], v252 offset:14848
    s_waitcnt vmcnt(23) lgkmcnt(8)
    v_mfma_f32_32x32x16_bf16 v[40:55], v[148:151], v[204:207], v[40:55]
    ds_read_b64_tr_b16 v[140:141], v250 offset:30720
    ds_read_b64_tr_b16 v[142:143], v250 offset:31744
    s_add_u32 m0, s53, 0x24000
    s_add_u32 s80, s52, 0x150080
    buffer_load_dwordx4 v36, s[16:19], s80 offen lds
    v_mfma_f32_32x32x16_bf16 v[56:71], v[120:123], v[204:207], v[56:71]
    ds_read_b64_tr_b16 v[144:145], v251 offset:30720
    ds_read_b64_tr_b16 v[146:147], v251 offset:31744
    buffer_load_dwordx4 v37, s[16:19], s80 offen offset:1024 lds
    s_waitcnt lgkmcnt(10)
    v_mfma_f32_32x32x16_bf16 v[88:103], v[124:127], v[204:207], v[88:103]
    ds_read_b64_tr_b16 v[148:149], v252 offset:15360
    ds_read_b64_tr_b16 v[150:151], v252 offset:15872
    buffer_load_dwordx4 v38, s[16:19], s80 offen offset:2048 lds
    s_waitcnt vmcnt(14) lgkmcnt(8)
    v_mfma_f32_32x32x16_bf16 v[40:55], v[128:131], v[208:211], v[40:55]
    s_barrier
    ds_read_b64_tr_b16 v[120:121], v250 offset:32768
    ds_read_b64_tr_b16 v[122:123], v250 offset:33792
    v_mfma_f32_32x32x16_bf16 v[56:71], v[132:135], v[208:211], v[56:71]
    ds_read_b64_tr_b16 v[124:125], v251 offset:32768
    ds_read_b64_tr_b16 v[126:127], v251 offset:33792
    buffer_load_dwordx4 v39, s[16:19], s80 offen offset:3072 lds
    s_waitcnt lgkmcnt(10)
    v_mfma_f32_32x32x16_bf16 v[88:103], v[136:139], v[208:211], v[88:103]
    ds_read_b64_tr_b16 v[128:129], v252 offset:16384
    ds_read_b64_tr_b16 v[130:131], v252 offset:16896
    s_waitcnt vmcnt(14) lgkmcnt(8)
    v_mfma_f32_32x32x16_bf16 v[40:55], v[140:143], v[212:215], v[40:55]
    ds_read_b64_tr_b16 v[132:133], v250 offset:34816
    ds_read_b64_tr_b16 v[134:135], v250 offset:35840
    s_xor_b32 s7, s40, 0x15000
    buffer_load_dwordx4 v[240:243], v2, s[28:31], s7 offen offset:2048
    v_mfma_f32_32x32x16_bf16 v[56:71], v[144:147], v[212:215], v[56:71]
    ds_read_b64_tr_b16 v[136:137], v251 offset:34816
    ds_read_b64_tr_b16 v[138:139], v251 offset:35840
    buffer_load_dwordx4 v[244:247], v2, s[28:31], s7 offen offset:3072
    s_waitcnt lgkmcnt(10)
    v_mfma_f32_32x32x16_bf16 v[88:103], v[148:151], v[212:215], v[88:103]
    ds_read_b64_tr_b16 v[140:141], v252 offset:17408
    ds_read_b64_tr_b16 v[142:143], v252 offset:17920
    s_xor_b32 s7, s40, 0x18000
    buffer_load_dwordx4 a[224:227], v2, s[28:31], s7 offen offset:2048
    s_waitcnt vmcnt(16) lgkmcnt(8)
    v_mfma_f32_32x32x16_bf16 v[40:55], v[120:123], v[216:219], v[40:55]
    ds_read_b64_tr_b16 v[144:145], v250 offset:36864
    ds_read_b64_tr_b16 v[146:147], v250 offset:37888
    v_mfma_f32_32x32x16_bf16 v[56:71], v[124:127], v[216:219], v[56:71]
    ds_read_b64_tr_b16 v[148:149], v251 offset:36864
    ds_read_b64_tr_b16 v[150:151], v251 offset:37888
    buffer_load_dwordx4 a[228:231], v2, s[28:31], s7 offen offset:3072
    s_waitcnt lgkmcnt(10)
    v_mfma_f32_32x32x16_bf16 v[88:103], v[128:131], v[216:219], v[88:103]
    ds_read_b64_tr_b16 v[120:121], v252 offset:18432
    ds_read_b64_tr_b16 v[122:123], v252 offset:18944
    s_waitcnt vmcnt(16) lgkmcnt(8)
    v_mfma_f32_32x32x16_bf16 v[40:55], v[132:135], v[220:223], v[40:55]
    ds_read_b64_tr_b16 v[124:125], v250 offset:38912
    ds_read_b64_tr_b16 v[126:127], v250 offset:39936
    s_xor_b32 s7, s40, 0x19000
    buffer_load_dwordx4 a[232:235], v2, s[28:31], s7 offen offset:2048
    v_mfma_f32_32x32x16_bf16 v[56:71], v[136:139], v[220:223], v[56:71]
    ds_read_b64_tr_b16 v[128:129], v251 offset:38912
    ds_read_b64_tr_b16 v[130:131], v251 offset:39936
    buffer_load_dwordx4 a[236:239], v2, s[28:31], s7 offen offset:3072
    s_waitcnt lgkmcnt(10)
    v_mfma_f32_32x32x16_bf16 v[88:103], v[140:143], v[220:223], v[88:103]
    ds_read_b64_tr_b16 v[132:133], v252 offset:19456
    ds_read_b64_tr_b16 v[134:135], v252 offset:19968
    s_xor_b32 s7, s40, 0x1c000
    buffer_load_dwordx4 a[240:243], v2, s[28:31], s7 offen offset:2048
    s_waitcnt vmcnt(18) lgkmcnt(8)
    v_mfma_f32_32x32x16_bf16 v[40:55], v[144:147], v[224:227], v[40:55]
    ds_read_b64_tr_b16 v[136:137], v250 offset:40960
    ds_read_b64_tr_b16 v[138:139], v250 offset:41984
    v_mfma_f32_32x32x16_bf16 v[56:71], v[148:151], v[224:227], v[56:71]
    ds_read_b64_tr_b16 v[140:141], v251 offset:40960
    ds_read_b64_tr_b16 v[142:143], v251 offset:41984
    buffer_load_dwordx4 a[244:247], v2, s[28:31], s7 offen offset:3072
    s_waitcnt lgkmcnt(10)
    v_mfma_f32_32x32x16_bf16 v[88:103], v[120:123], v[224:227], v[88:103]
    ds_read_b64_tr_b16 v[144:145], v252 offset:20480
    ds_read_b64_tr_b16 v[146:147], v252 offset:20992
    s_waitcnt vmcnt(18) lgkmcnt(8)
    v_mfma_f32_32x32x16_bf16 v[40:55], v[124:127], v[228:231], v[40:55]
    ds_read_b64_tr_b16 v[148:149], v250 offset:43008
    ds_read_b64_tr_b16 v[150:151], v250 offset:44032
    s_xor_b32 s7, s40, 0x1d000
    buffer_load_dwordx4 a[248:251], v2, s[28:31], s7 offen offset:2048
    v_mfma_f32_32x32x16_bf16 v[56:71], v[128:131], v[228:231], v[56:71]
    ds_read_b64_tr_b16 v[120:121], v251 offset:43008
    ds_read_b64_tr_b16 v[122:123], v251 offset:44032
    buffer_load_dwordx4 a[252:255], v2, s[28:31], s7 offen offset:3072
    s_waitcnt lgkmcnt(10)
    v_mfma_f32_32x32x16_bf16 v[88:103], v[132:135], v[228:231], v[88:103]
    ds_read_b64_tr_b16 v[124:125], v252 offset:21504
    ds_read_b64_tr_b16 v[126:127], v252 offset:22016
    buffer_load_dwordx4 v[104:107], v2, s[28:31], s78 offen offset:0 sc1
    s_waitcnt vmcnt(20) lgkmcnt(8)
    v_mfma_f32_32x32x16_bf16 v[40:55], v[136:139], v[232:235], v[40:55]
    ds_read_b64_tr_b16 v[128:129], v250 offset:45056
    ds_read_b64_tr_b16 v[130:131], v250 offset:46080
    v_mfma_f32_32x32x16_bf16 v[56:71], v[140:143], v[232:235], v[56:71]
    ds_read_b64_tr_b16 v[132:133], v251 offset:45056
    ds_read_b64_tr_b16 v[134:135], v251 offset:46080
    buffer_load_dwordx4 v[108:111], v2, s[28:31], s78 offen offset:1024 sc1
    s_waitcnt lgkmcnt(10)
    v_mfma_f32_32x32x16_bf16 v[88:103], v[144:147], v[232:235], v[88:103]
    ds_read_b64_tr_b16 v[136:137], v252 offset:22528
    ds_read_b64_tr_b16 v[138:139], v252 offset:23040
    s_add_u32 m0, s53, 0x0
    s_add_u32 s80, s52, 0x100
    buffer_load_dwordx4 v36, s[16:19], s80 offen lds
    s_waitcnt vmcnt(21) lgkmcnt(8)
    v_mfma_f32_32x32x16_bf16 v[40:55], v[148:151], v[236:239], v[40:55]
    ds_read_b64_tr_b16 v[140:141], v250 offset:47104
    ds_read_b64_tr_b16 v[142:143], v250 offset:48128
    buffer_load_dwordx4 v37, s[16:19], s80 offen offset:1024 lds
    v_mfma_f32_32x32x16_bf16 v[56:71], v[120:123], v[236:239], v[56:71]
    ds_read_b64_tr_b16 v[144:145], v251 offset:47104
    ds_read_b64_tr_b16 v[146:147], v251 offset:48128
    buffer_load_dwordx4 v38, s[16:19], s80 offen offset:2048 lds
    s_waitcnt lgkmcnt(10)
    v_mfma_f32_32x32x16_bf16 v[88:103], v[124:127], v[236:239], v[88:103]
    ds_read_b64_tr_b16 v[148:149], v252 offset:23552
    ds_read_b64_tr_b16 v[150:151], v252 offset:24064
    buffer_load_dwordx4 v39, s[16:19], s80 offen offset:3072 lds
    s_waitcnt vmcnt(15) lgkmcnt(8)
    v_mfma_f32_32x32x16_bf16 v[40:55], v[128:131], v[240:243], v[40:55]
    s_barrier
    ds_read_b64_tr_b16 v[120:121], v250 offset:49152
    ds_read_b64_tr_b16 v[122:123], v250 offset:50176
    v_mfma_f32_32x32x16_bf16 v[56:71], v[132:135], v[240:243], v[56:71]
    ds_read_b64_tr_b16 v[124:125], v251 offset:49152
    ds_read_b64_tr_b16 v[126:127], v251 offset:50176
    s_add_u32 m0, s53, 0x18000
    s_add_u32 s80, s52, 0x70100
    buffer_load_dwordx4 v36, s[16:19], s80 offen lds
    s_waitcnt lgkmcnt(10)
    v_mfma_f32_32x32x16_bf16 v[88:103], v[136:139], v[240:243], v[88:103]
    ds_read_b64_tr_b16 v[128:129], v252 offset:24576
    ds_read_b64_tr_b16 v[130:131], v252 offset:25088
    buffer_load_dwordx4 v37, s[16:19], s80 offen offset:1024 lds
    s_waitcnt vmcnt(16) lgkmcnt(8)
    v_mfma_f32_32x32x16_bf16 v[40:55], v[140:143], v[244:247], v[40:55]
    ds_read_b64_tr_b16 v[132:133], v250 offset:51200
    ds_read_b64_tr_b16 v[134:135], v250 offset:52224
    buffer_load_dwordx4 v38, s[16:19], s80 offen offset:2048 lds
    v_mfma_f32_32x32x16_bf16 v[56:71], v[144:147], v[244:247], v[56:71]
    ds_read_b64_tr_b16 v[136:137], v251 offset:51200
    ds_read_b64_tr_b16 v[138:139], v251 offset:52224
    buffer_load_dwordx4 v39, s[16:19], s80 offen offset:3072 lds
    s_waitcnt lgkmcnt(10)
    v_mfma_f32_32x32x16_bf16 v[88:103], v[148:151], v[244:247], v[88:103]
    ds_read_b64_tr_b16 v[140:141], v252 offset:25600
    ds_read_b64_tr_b16 v[142:143], v252 offset:26112
    s_add_u32 m0, s53, 0x4000
    s_add_u32 s80, s52, 0xe0100
    buffer_load_dwordx4 v36, s[16:19], s80 offen lds
    s_waitcnt vmcnt(18) lgkmcnt(8)
    v_mfma_f32_32x32x16_bf16 v[40:55], v[120:123], a[224:227], v[40:55]
    ds_read_b64_tr_b16 v[144:145], v250 offset:53248
    ds_read_b64_tr_b16 v[146:147], v250 offset:54272
    v_mfma_f32_32x32x16_bf16 v[56:71], v[124:127], a[224:227], v[56:71]
    ds_read_b64_tr_b16 v[148:149], v251 offset:53248
    ds_read_b64_tr_b16 v[150:151], v251 offset:54272
    buffer_load_dwordx4 v37, s[16:19], s80 offen offset:1024 lds
    s_waitcnt lgkmcnt(10)
    v_mfma_f32_32x32x16_bf16 v[88:103], v[128:131], a[224:227], v[88:103]
    ds_read_b64_tr_b16 v[120:121], v252 offset:26624
    ds_read_b64_tr_b16 v[122:123], v252 offset:27136
    buffer_load_dwordx4 v38, s[16:19], s80 offen offset:2048 lds
    s_waitcnt vmcnt(19) lgkmcnt(8)
    v_mfma_f32_32x32x16_bf16 v[40:55], v[132:135], a[228:231], v[40:55]
    ds_read_b64_tr_b16 v[124:125], v250 offset:55296
    ds_read_b64_tr_b16 v[126:127], v250 offset:56320
    buffer_load_dwordx4 v39, s[16:19], s80 offen offset:3072 lds
    v_mfma_f32_32x32x16_bf16 v[56:71], v[136:139], a[228:231], v[56:71]
    ds_read_b64_tr_b16 v[128:129], v251 offset:55296
    ds_read_b64_tr_b16 v[130:131], v251 offset:56320
    s_add_u32 m0, s53, 0x1c000
    s_add_u32 s80, s52, 0x150100
    buffer_load_dwordx4 v36, s[16:19], s80 offen lds
    s_waitcnt lgkmcnt(10)
    v_mfma_f32_32x32x16_bf16 v[88:103], v[140:143], a[228:231], v[88:103]
    ds_read_b64_tr_b16 v[132:133], v252 offset:27648
    ds_read_b64_tr_b16 v[134:135], v252 offset:28160
    buffer_load_dwordx4 v37, s[16:19], s80 offen offset:1024 lds
    s_waitcnt vmcnt(21) lgkmcnt(8)
    v_mfma_f32_32x32x16_bf16 v[40:55], v[144:147], a[232:235], v[40:55]
    ds_read_b64_tr_b16 v[136:137], v250 offset:57344
    ds_read_b64_tr_b16 v[138:139], v250 offset:58368
    v_mfma_f32_32x32x16_bf16 v[56:71], v[148:151], a[232:235], v[56:71]
    ds_read_b64_tr_b16 v[140:141], v251 offset:57344
    ds_read_b64_tr_b16 v[142:143], v251 offset:58368
    buffer_load_dwordx4 v38, s[16:19], s80 offen offset:2048 lds
    s_waitcnt lgkmcnt(10)
    v_mfma_f32_32x32x16_bf16 v[88:103], v[120:123], a[232:235], v[88:103]
    ds_read_b64_tr_b16 v[144:145], v252 offset:28672
    ds_read_b64_tr_b16 v[146:147], v252 offset:29184
    buffer_load_dwordx4 v39, s[16:19], s80 offen offset:3072 lds
    s_waitcnt vmcnt(22) lgkmcnt(8)
    v_mfma_f32_32x32x16_bf16 v[40:55], v[124:127], a[236:239], v[40:55]
    ds_read_b64_tr_b16 v[148:149], v250 offset:59392
    ds_read_b64_tr_b16 v[150:151], v250 offset:60416
    v_mfma_f32_32x32x16_bf16 v[56:71], v[128:131], a[236:239], v[56:71]
    ds_read_b64_tr_b16 v[120:121], v251 offset:59392
    ds_read_b64_tr_b16 v[122:123], v251 offset:60416
    s_waitcnt lgkmcnt(10)
    v_mfma_f32_32x32x16_bf16 v[88:103], v[132:135], a[236:239], v[88:103]
    ds_read_b64_tr_b16 v[124:125], v252 offset:29696
    ds_read_b64_tr_b16 v[126:127], v252 offset:30208
    s_waitcnt vmcnt(21) lgkmcnt(8)
    v_mfma_f32_32x32x16_bf16 v[40:55], v[136:139], a[240:243], v[40:55]
    ds_read_b64_tr_b16 v[128:129], v250 offset:61440
    ds_read_b64_tr_b16 v[130:131], v250 offset:62464
    s_waitcnt vmcnt(16)
    v_add_f32 v104, v104, v108
    v_add_f32 v105, v105, v109
    v_add_f32 v106, v106, v110
    v_add_f32 v107, v107, v111
    v_mov_b32 v110, 0x3727c5ac
    v_permlane32_swap_b32 v104, v105
    v_add_f32 v108, v104, v105
    v_permlane32_swap_b32 v106, v107
    v_add_f32 v109, v106, v107
    s_nop 0
    s_nop 0
    v_permlane16_swap_b32 v108, v109
    v_add_f32 v104, v108, v109
    s_nop 1
    v_add_f32_dpp v105, v104, v104 row_ror:8 row_mask:0xf bank_mask:0xf
    v_mfma_f32_32x32x16_bf16 v[56:71], v[140:143], a[240:243], v[56:71]
    ds_read_b64_tr_b16 v[132:133], v251 offset:61440
    ds_read_b64_tr_b16 v[134:135], v251 offset:62464
    ds_bpermute_b32 v106, v253, v105
    s_waitcnt lgkmcnt(11)
    v_mfma_f32_32x32x16_bf16 v[88:103], v[144:147], a[240:243], v[88:103]
    ds_read_b64_tr_b16 v[136:137], v252 offset:30720
    ds_read_b64_tr_b16 v[138:139], v252 offset:31232
    s_waitcnt lgkmcnt(9)
    v_mfma_f32_32x32x16_bf16 v[40:55], v[148:151], a[244:247], v[40:55]
    ds_read_b64_tr_b16 v[140:141], v250 offset:63488
    ds_read_b64_tr_b16 v[142:143], v250 offset:64512
    v_mfma_f32_32x32x16_bf16 v[56:71], v[120:123], a[244:247], v[56:71]
    ds_read_b64_tr_b16 v[144:145], v251 offset:63488
    ds_read_b64_tr_b16 v[146:147], v251 offset:64512
    s_waitcnt lgkmcnt(11)
    v_mfma_f32_32x32x16_bf16 v[88:103], v[124:127], a[244:247], v[88:103]
    ds_read_b64_tr_b16 v[148:149], v252 offset:31744
    ds_read_b64_tr_b16 v[150:151], v252 offset:32256
    s_waitcnt lgkmcnt(9)
    v_mfma_f32_32x32x16_bf16 v[40:55], v[128:131], a[248:251], v[40:55]
    s_waitcnt vmcnt(8)
    s_barrier
    ds_read_b64_tr_b16 v[120:121], v250 offset:0
    ds_read_b64_tr_b16 v[122:123], v250 offset:1024
    v_mfma_f32_32x32x16_bf16 v[56:71], v[132:135], a[248:251], v[56:71]
    ds_read_b64_tr_b16 v[124:125], v250 offset:2048
    ds_read_b64_tr_b16 v[126:127], v250 offset:3072
    s_waitcnt lgkmcnt(10)
    v_mfma_f32_32x32x16_bf16 v[88:103], v[136:139], a[248:251], v[88:103]
    ds_read_b64_tr_b16 v[128:129], v250 offset:4096
    ds_read_b64_tr_b16 v[130:131], v250 offset:5120
    v_fmac_f32 v110, 0x3b000000, v106
    v_rsq_f32 v25, v110
    s_nop 0
    v_mul_f32 v248, 0xbfb8aa3b, v25
    s_waitcnt lgkmcnt(8)
    v_mfma_f32_32x32x16_bf16 v[40:55], v[140:143], a[252:255], v[40:55]
    ds_read_b64_tr_b16 v[132:133], v250 offset:6144
    ds_read_b64_tr_b16 v[134:135], v250 offset:7168
    v_mfma_f32_32x32x16_bf16 v[56:71], v[144:147], a[252:255], v[56:71]
    ds_read_b64_tr_b16 v[136:137], v250 offset:8192
    ds_read_b64_tr_b16 v[138:139], v250 offset:9216
    s_waitcnt lgkmcnt(10)
    v_mfma_f32_32x32x16_bf16 v[88:103], v[148:151], a[252:255], v[88:103]
    ds_read_b64_tr_b16 v[140:141], v250 offset:10240
    ds_read_b64_tr_b16 v[142:143], v250 offset:11264
    s_waitcnt lgkmcnt(8)
    v_mfma_f32_32x32x16_bf16 v[72:87], v[120:123], v[152:155], 0
    ds_read_b64_tr_b16 v[144:145], v250 offset:12288
    ds_read_b64_tr_b16 v[146:147], v250 offset:13312
    v_mfma_f32_32x32x16_bf16 v[72:87], v[124:127], v[156:159], v[72:87]
    ds_read_b64_tr_b16 v[148:149], v250 offset:14336
    ds_read_b64_tr_b16 v[150:151], v250 offset:15360
    v_mul_f32 v112, v248, v40
    v_mul_f32 v113, v248, v41
    v_mul_f32 v114, v248, v42
    v_mul_f32 v115, v248, v43
    v_mul_f32 v116, v248, v44
    v_mul_f32 v117, v248, v45
    v_mul_f32 v118, v248, v46
    v_mul_f32 v119, v248, v47
    v_exp_f32 v112, v112
    v_exp_f32 v113, v113
    s_waitcnt lgkmcnt(8)
    v_mfma_f32_32x32x16_bf16 v[72:87], v[128:131], v[160:163], v[72:87]
    ds_read_b64_tr_b16 v[120:121], v251 offset:0
    ds_read_b64_tr_b16 v[122:123], v251 offset:1024
    v_exp_f32 v114, v114
    v_exp_f32 v115, v115
    v_exp_f32 v116, v116
    v_exp_f32 v117, v117
    v_exp_f32 v118, v118
    v_exp_f32 v119, v119
    v_mfma_f32_32x32x16_bf16 v[72:87], v[132:135], v[164:167], v[72:87]
    ds_read_b64_tr_b16 v[124:125], v251 offset:2048
    ds_read_b64_tr_b16 v[126:127], v251 offset:3072
    v_add_f32 v112, 1.0, v112
    v_add_f32 v113, 1.0, v113
    v_add_f32 v114, 1.0, v114
    v_add_f32 v115, 1.0, v115
    v_add_f32 v116, 1.0, v116
    v_add_f32 v117, 1.0, v117
    v_add_f32 v118, 1.0, v118
    v_add_f32 v119, 1.0, v119
    v_rcp_f32 v112, v112
    v_rcp_f32 v113, v113
    s_waitcnt lgkmcnt(8)
    v_mfma_f32_32x32x16_bf16 v[72:87], v[136:139], v[168:171], v[72:87]
    ds_read_b64_tr_b16 v[128:129], v251 offset:4096
    ds_read_b64_tr_b16 v[130:131], v251 offset:5120
    v_rcp_f32 v114, v114
    v_rcp_f32 v115, v115
    v_rcp_f32 v116, v116
    v_rcp_f32 v117, v117
    v_rcp_f32 v118, v118
    v_rcp_f32 v119, v119
    v_mfma_f32_32x32x16_bf16 v[72:87], v[140:143], v[172:175], v[72:87]
    ds_read_b64_tr_b16 v[132:133], v251 offset:6144
    ds_read_b64_tr_b16 v[134:135], v251 offset:7168
    v_mul_f32 v112, v112, v40
    v_mul_f32 v113, v113, v41
    v_mul_f32 v114, v114, v42
    v_mul_f32 v115, v115, v43
    v_mul_f32 v116, v116, v44
    v_mul_f32 v117, v117, v45
    v_mul_f32 v118, v118, v46
    v_mul_f32 v119, v119, v47
    v_cvt_pk_bf16_f32 v104, v112, v113
    v_cvt_pk_bf16_f32 v105, v114, v115
    v_cvt_pk_bf16_f32 v106, v116, v117
    s_waitcnt lgkmcnt(8)
    v_mfma_f32_32x32x16_bf16 v[72:87], v[144:147], v[176:179], v[72:87]
    ds_read_b64_tr_b16 v[136:137], v251 offset:8192
    ds_read_b64_tr_b16 v[138:139], v251 offset:9216
    v_cvt_pk_bf16_f32 v107, v118, v119
    v_mul_f32 v112, v248, v48
    v_mul_f32 v113, v248, v49
    v_mul_f32 v114, v248, v50
    v_mul_f32 v115, v248, v51
    v_mul_f32 v116, v248, v52
    v_mul_f32 v117, v248, v53
    v_mul_f32 v118, v248, v54
    v_mul_f32 v119, v248, v55
    v_exp_f32 v112, v112
    v_mfma_f32_32x32x16_bf16 v[72:87], v[148:151], v[180:183], v[72:87]
    ds_read_b64_tr_b16 v[140:141], v251 offset:10240
    ds_read_b64_tr_b16 v[142:143], v251 offset:11264
    buffer_store_dwordx4 v[104:107], v2, s[28:31], s3 offen offset:0 sc1
    v_exp_f32 v113, v113
    v_exp_f32 v114, v114
    v_exp_f32 v115, v115
    v_exp_f32 v116, v116
    v_exp_f32 v117, v117
    v_exp_f32 v118, v118
    s_waitcnt lgkmcnt(8)
    v_mfma_f32_32x32x16_bf16 v[72:87], v[120:123], v[184:187], v[72:87]
    ds_read_b64_tr_b16 v[144:145], v251 offset:12288
    ds_read_b64_tr_b16 v[146:147], v251 offset:13312
    v_exp_f32 v119, v119
    v_add_f32 v112, 1.0, v112
    v_add_f32 v113, 1.0, v113
    v_add_f32 v114, 1.0, v114
    v_add_f32 v115, 1.0, v115
    v_add_f32 v116, 1.0, v116
    v_add_f32 v117, 1.0, v117
    v_add_f32 v118, 1.0, v118
    v_add_f32 v119, 1.0, v119
    v_rcp_f32 v112, v112
    v_mfma_f32_32x32x16_bf16 v[72:87], v[124:127], v[188:191], v[72:87]
    ds_read_b64_tr_b16 v[148:149], v251 offset:14336
    ds_read_b64_tr_b16 v[150:151], v251 offset:15360
    v_rcp_f32 v113, v113
    v_rcp_f32 v114, v114
    v_rcp_f32 v115, v115
    v_rcp_f32 v116, v116
    v_rcp_f32 v117, v117
    v_rcp_f32 v118, v118
    s_waitcnt lgkmcnt(8)
    v_mfma_f32_32x32x16_bf16 v[72:87], v[128:131], v[192:195], v[72:87]
    s_waitcnt vmcnt(1)
    s_barrier
    ds_read_b64_tr_b16 v[120:121], v250 offset:16384
    ds_read_b64_tr_b16 v[122:123], v250 offset:17408
    v_rcp_f32 v119, v119
    v_mul_f32 v112, v112, v48
    v_mul_f32 v113, v113, v49
    v_mul_f32 v114, v114, v50
    v_mul_f32 v115, v115, v51
    v_mul_f32 v116, v116, v52
    v_mul_f32 v117, v117, v53
    v_mul_f32 v118, v118, v54
    v_mul_f32 v119, v119, v55
    v_cvt_pk_bf16_f32 v108, v112, v113
    v_mfma_f32_32x32x16_bf16 v[72:87], v[132:135], v[196:199], v[72:87]
    ds_read_b64_tr_b16 v[124:125], v250 offset:18432
    ds_read_b64_tr_b16 v[126:127], v250 offset:19456
    v_cvt_pk_bf16_f32 v109, v114, v115
    v_cvt_pk_bf16_f32 v110, v116, v117
    v_cvt_pk_bf16_f32 v111, v118, v119
    v_mul_f32 v112, v248, v56
    v_mul_f32 v113, v248, v57
    v_mul_f32 v114, v248, v58
    v_mul_f32 v115, v248, v59
    v_mul_f32 v116, v248, v60
    v_mul_f32 v117, v248, v61
    v_mul_f32 v118, v248, v62
    v_mul_f32 v119, v248, v63
    s_waitcnt lgkmcnt(8)
    v_mfma_f32_32x32x16_bf16 v[72:87], v[136:139], v[200:203], v[72:87]
    ds_read_b64_tr_b16 v[128:129], v250 offset:20480
    ds_read_b64_tr_b16 v[130:131], v250 offset:21504
    buffer_store_dwordx4 v[108:111], v2, s[28:31], s3 offen offset:1024 sc1
    v_exp_f32 v112, v112
    v_exp_f32 v113, v113
    v_exp_f32 v114, v114
    v_exp_f32 v115, v115
    v_exp_f32 v116, v116
    v_exp_f32 v117, v117
    v_mfma_f32_32x32x16_bf16 v[72:87], v[140:143], v[204:207], v[72:87]
    ds_read_b64_tr_b16 v[132:133], v250 offset:22528
    ds_read_b64_tr_b16 v[134:135], v250 offset:23552
    v_exp_f32 v118, v118
    v_exp_f32 v119, v119
    v_add_f32 v112, 1.0, v112
    v_add_f32 v113, 1.0, v113
    v_add_f32 v114, 1.0, v114
    v_add_f32 v115, 1.0, v115
    v_add_f32 v116, 1.0, v116
    v_add_f32 v117, 1.0, v117
    v_add_f32 v118, 1.0, v118
    s_waitcnt lgkmcnt(8)
    v_mfma_f32_32x32x16_bf16 v[72:87], v[144:147], v[208:211], v[72:87]
    ds_read_b64_tr_b16 v[136:137], v250 offset:24576
    ds_read_b64_tr_b16 v[138:139], v250 offset:25600
    v_add_f32 v119, 1.0, v119
    v_rcp_f32 v112, v112
    v_rcp_f32 v113, v113
    v_rcp_f32 v114, v114
    v_rcp_f32 v115, v115
    v_rcp_f32 v116, v116
    v_mfma_f32_32x32x16_bf16 v[72:87], v[148:151], v[212:215], v[72:87]
    ds_read_b64_tr_b16 v[140:141], v250 offset:26624
    ds_read_b64_tr_b16 v[142:143], v250 offset:27648
    v_rcp_f32 v117, v117
    v_rcp_f32 v118, v118
    v_rcp_f32 v119, v119
    v_mul_f32 v112, v112, v56
    v_mul_f32 v113, v113, v57
    v_mul_f32 v114, v114, v58
    v_mul_f32 v115, v115, v59
    v_mul_f32 v116, v116, v60
    s_waitcnt lgkmcnt(8)
    v_mfma_f32_32x32x16_bf16 v[72:87], v[120:123], v[216:219], v[72:87]
    ds_read_b64_tr_b16 v[144:145], v250 offset:28672
    ds_read_b64_tr_b16 v[146:147], v250 offset:29696
    v_mul_f32 v117, v117, v61
    v_mul_f32 v118, v118, v62
    v_mul_f32 v119, v119, v63
    v_cvt_pk_bf16_f32 v104, v112, v113
    v_cvt_pk_bf16_f32 v105, v114, v115
    v_cvt_pk_bf16_f32 v106, v116, v117
    v_cvt_pk_bf16_f32 v107, v118, v119
    v_mul_f32 v112, v248, v64
    v_mul_f32 v113, v248, v65
    v_mul_f32 v114, v248, v66
    v_mul_f32 v115, v248, v67
    v_mfma_f32_32x32x16_bf16 v[72:87], v[124:127], v[220:223], v[72:87]
    ds_read_b64_tr_b16 v[148:149], v250 offset:30720
    ds_read_b64_tr_b16 v[150:151], v250 offset:31744
    buffer_store_dwordx4 v[104:107], v2, s[28:31], s4 offen offset:0 sc1
    v_mul_f32 v116, v248, v68
    v_mul_f32 v117, v248, v69
    v_mul_f32 v118, v248, v70
    v_mul_f32 v119, v248, v71
    v_exp_f32 v112, v112
    v_exp_f32 v113, v113
    v_exp_f32 v114, v114
    v_exp_f32 v115, v115
    s_waitcnt lgkmcnt(8)
    v_mfma_f32_32x32x16_bf16 v[72:87], v[128:131], v[224:227], v[72:87]
    ds_read_b64_tr_b16 v[120:121], v251 offset:16384
    ds_read_b64_tr_b16 v[122:123], v251 offset:17408
    v_exp_f32 v116, v116
    v_exp_f32 v117, v117
    v_exp_f32 v118, v118
    v_exp_f32 v119, v119
    v_add_f32 v112, 1.0, v112
    v_add_f32 v113, 1.0, v113
    v_add_f32 v114, 1.0, v114
    v_mfma_f32_32x32x16_bf16 v[72:87], v[132:135], v[228:231], v[72:87]
    ds_read_b64_tr_b16 v[124:125], v251 offset:18432
    ds_read_b64_tr_b16 v[126:127], v251 offset:19456
    v_add_f32 v115, 1.0, v115
    v_add_f32 v116, 1.0, v116
    v_add_f32 v117, 1.0, v117
    v_add_f32 v118, 1.0, v118
    v_add_f32 v119, 1.0, v119
    v_rcp_f32 v112, v112
    v_rcp_f32 v113, v113
    v_rcp_f32 v114, v114
    s_waitcnt lgkmcnt(8)
    v_mfma_f32_32x32x16_bf16 v[72:87], v[136:139], v[232:235], v[72:87]
    ds_read_b64_tr_b16 v[128:129], v251 offset:20480
    ds_read_b64_tr_b16 v[130:131], v251 offset:21504
    v_rcp_f32 v115, v115
    v_rcp_f32 v116, v116
    v_rcp_f32 v117, v117
    v_rcp_f32 v118, v118
    v_rcp_f32 v119, v119
    v_mul_f32 v112, v112, v64
    v_mfma_f32_32x32x16_bf16 v[72:87], v[140:143], v[236:239], v[72:87]
    ds_read_b64_tr_b16 v[132:133], v251 offset:22528
    ds_read_b64_tr_b16 v[134:135], v251 offset:23552
    v_mul_f32 v113, v113, v65
    v_mul_f32 v114, v114, v66
    v_mul_f32 v115, v115, v67
    v_mul_f32 v116, v116, v68
    v_mul_f32 v117, v117, v69
    v_mul_f32 v118, v118, v70
    v_mul_f32 v119, v119, v71
    v_cvt_pk_bf16_f32 v108, v112, v113
    v_cvt_pk_bf16_f32 v109, v114, v115
    v_cvt_pk_bf16_f32 v110, v116, v117
    v_cvt_pk_bf16_f32 v111, v118, v119
    s_waitcnt vmcnt(1)
    s_cmp_lg_u32 s82, 0
    s_cbranch_scc1 L_wt_14
    buffer_store_dwordx2 v[16:17], v10, s[28:31], s44 offen
L_wt_14_r:
    s_add_u32 s44, s44, 0x2000
    s_waitcnt lgkmcnt(8)
    v_mfma_f32_32x32x16_bf16 v[72:87], v[144:147], v[240:243], v[72:87]
    ds_read_b64_tr_b16 v[136:137], v251 offset:24576
    ds_read_b64_tr_b16 v[138:139], v251 offset:25600
    v_mul_f32 v112, v248, v88
    v_mul_f32 v113, v248, v89
    v_mul_f32 v114, v248, v90
    v_mul_f32 v115, v248, v91
    v_mul_f32 v116, v248, v92
    v_mul_f32 v117, v248, v93
    v_mul_f32 v118, v248, v94
    v_mul_f32 v119, v248, v95
    v_exp_f32 v112, v112
    v_exp_f32 v113, v113
    v_mfma_f32_32x32x16_bf16 v[72:87], v[148:151], v[244:247], v[72:87]
    ds_read_b64_tr_b16 v[140:141], v251 offset:26624
    ds_read_b64_tr_b16 v[142:143], v251 offset:27648
    buffer_store_dwordx4 v[108:111], v2, s[28:31], s4 offen offset:1024 sc1
    v_exp_f32 v114, v114
    v_exp_f32 v115, v115
    v_exp_f32 v116, v116
    v_exp_f32 v117, v117
    v_exp_f32 v118, v118
    v_exp_f32 v119, v119
    s_waitcnt lgkmcnt(8)
    v_mfma_f32_32x32x16_bf16 v[72:87], v[120:123], a[224:227], v[72:87]
    ds_read_b64_tr_b16 v[144:145], v251 offset:28672
    ds_read_b64_tr_b16 v[146:147], v251 offset:29696
    v_add_f32 v112, 1.0, v112
    v_add_f32 v113, 1.0, v113
    v_add_f32 v114, 1.0, v114
    v_add_f32 v115, 1.0, v115
    v_add_f32 v116, 1.0, v116
    v_add_f32 v117, 1.0, v117
    v_add_f32 v118, 1.0, v118
    v_add_f32 v119, 1.0, v119
    v_rcp_f32 v112, v112
    v_rcp_f32 v113, v113
    v_mfma_f32_32x32x16_bf16 v[72:87], v[124:127], a[228:231], v[72:87]
    ds_read_b64_tr_b16 v[148:149], v251 offset:30720
    ds_read_b64_tr_b16 v[150:151], v251 offset:31744
    v_rcp_f32 v114, v114
    v_rcp_f32 v115, v115
    v_rcp_f32 v116, v116
    v_rcp_f32 v117, v117
    v_rcp_f32 v118, v118
    v_rcp_f32 v119, v119
    s_waitcnt lgkmcnt(8)
    v_mfma_f32_32x32x16_bf16 v[72:87], v[128:131], a[232:235], v[72:87]
    v_mul_f32 v112, v112, v88
    v_mul_f32 v113, v113, v89
    v_mul_f32 v114, v114, v90
    v_mul_f32 v115, v115, v91
    v_mul_f32 v116, v116, v92
    v_mul_f32 v117, v117, v93
    v_mul_f32 v118, v118, v94
    v_mul_f32 v119, v119, v95
    v_cvt_pk_bf16_f32 v104, v112, v113
    v_cvt_pk_bf16_f32 v105, v114, v115
    v_cvt_pk_bf16_f32 v106, v116, v117
    s_mul_i32 s77, s64, 256
    s_add_u32 s77, s77, 0x1024000
    s_mov_b64 exec, 0xffff
    buffer_load_dwordx4 v[20:23], v2, s[28:31], s77 offen sc1
    s_mov_b64 exec, -1
    v_mfma_f32_32x32x16_bf16 v[72:87], v[132:135], a[236:239], v[72:87]
    v_cvt_pk_bf16_f32 v107, v118, v119
    s_waitcnt lgkmcnt(4)
    v_mfma_f32_32x32x16_bf16 v[72:87], v[136:139], a[240:243], v[72:87]
    buffer_store_dwordx4 v[104:107], v2, s[28:31], s4 offen offset:2048 sc1
    v_mfma_f32_32x32x16_bf16 v[72:87], v[140:143], a[244:247], v[72:87]
    s_waitcnt lgkmcnt(0)
    v_mfma_f32_32x32x16_bf16 v[72:87], v[144:147], a[248:251], v[72:87]
    s_waitcnt vmcnt(1)
    s_mov_b64 exec, 0xffff
    v_cmp_ne_u64 vcc, s[58:59], v[20:21]
    v_cmp_ne_u64 s[60:61], s[58:59], v[22:23]
    s_mov_b64 exec, -1
    s_or_b32 s70, vcc_lo, s60
    s_cbranch_scc0 L_spin_f0_15_d
    s_mov_b32 s71, 0x40000
L_spin_f0_15_l:
    s_mov_b64 exec, 0xffff
    buffer_load_dwordx4 v[20:23], v2, s[28:31], s77 offen sc1
    s_waitcnt vmcnt(0)
    v_cmp_ne_u64 vcc, s[58:59], v[20:21]
    v_cmp_ne_u64 s[60:61], s[58:59], v[22:23]
    s_mov_b64 exec, -1
    s_or_b32 s70, vcc_lo, s60
    s_cbranch_scc0 L_spin_f0_15_d
    s_sub_u32 s71, s71, 1
    s_cbranch_scc0 L_spin_f0_15_l
L_spin_f0_15_d:
    v_mfma_f32_32x32x16_bf16 v[72:87], v[148:151], a[252:255], v[72:87]
    s_add_u32 s49, s47, 0x0
    buffer_load_dwordx4 v[152:155], v2, s[28:31], s49 offen offset:0 sc1
    s_nop 9
    v_pk_mul_f32 v[112:113], v[72:73], v[248:249] op_sel_hi:[1,0]
    v_pk_mul_f32 v[114:115], v[74:75], v[248:249] op_sel_hi:[1,0]
    v_pk_mul_f32 v[116:117], v[76:77], v[248:249] op_sel_hi:[1,0]
    v_pk_mul_f32 v[118:119], v[78:79], v[248:249] op_sel_hi:[1,0]
    v_exp_f32 v112, v112
    v_exp_f32 v113, v113
    s_add_u32 s50, s48, 0x0
    buffer_load_dwordx4 v[156:159], v2, s[28:31], s50 offen offset:0 sc1
    v_exp_f32 v114, v114
    v_exp_f32 v115, v115
    v_exp_f32 v116, v116
    v_exp_f32 v117, v117
    v_exp_f32 v118, v118
    v_exp_f32 v119, v119
    buffer_load_dwordx4 v[160:163], v2, s[28:31], s49 offen offset:1024 sc1
    v_pk_add_f32 v[112:113], v[112:113], 1.0 op_sel_hi:[1,0]
    v_pk_add_f32 v[114:115], v[114:115], 1.0 op_sel_hi:[1,0]
    v_pk_add_f32 v[116:117], v[116:117], 1.0 op_sel_hi:[1,0]
    v_pk_add_f32 v[118:119], v[118:119], 1.0 op_sel_hi:[1,0]
    v_rcp_f32 v112, v112
    v_rcp_f32 v113, v113
    buffer_load_dwordx4 v[164:167], v2, s[28:31], s50 offen offset:1024 sc1
    v_rcp_f32 v114, v114
    v_rcp_f32 v115, v115
    v_rcp_f32 v116, v116
    v_rcp_f32 v117, v117
    v_rcp_f32 v118, v118
    v_rcp_f32 v119, v119
    s_add_u32 s49, s47, 0x1000
    buffer_load_dwordx4 v[168:171], v2, s[28:31], s49 offen offset:0 sc1
    v_pk_mul_f32 v[112:113], v[112:113], v[72:73]
    v_pk_mul_f32 v[114:115], v[114:115], v[74:75]
    v_pk_mul_f32 v[116:117], v[116:117], v[76:77]
    v_pk_mul_f32 v[118:119], v[118:119], v[78:79]
    v_cvt_pk_bf16_f32 v104, v112, v113
    v_cvt_pk_bf16_f32 v105, v114, v115
    s_add_u32 s50, s48, 0x1000
    buffer_load_dwordx4 v[172:175], v2, s[28:31], s50 offen offset:0 sc1
    v_cvt_pk_bf16_f32 v106, v116, v117
    v_cvt_pk_bf16_f32 v107, v118, v119
    s_cmp_lg_u32 s82, 0
    s_cbranch_scc1 L_wt_16
    buffer_store_dwordx4 v[104:107], v2, s[28:31], s3 offen offset:2048
L_wt_16_r:
    v_pk_mul_f32 v[112:113], v[80:81], v[248:249] op_sel_hi:[1,0]
    v_pk_mul_f32 v[114:115], v[82:83], v[248:249] op_sel_hi:[1,0]
    v_pk_mul_f32 v[116:117], v[84:85], v[248:249] op_sel_hi:[1,0]
    buffer_load_dwordx4 v[176:179], v2, s[28:31], s49 offen offset:1024 sc1
    v_pk_mul_f32 v[118:119], v[86:87], v[248:249] op_sel_hi:[1,0]
    v_exp_f32 v112, v112
    v_exp_f32 v113, v113
    v_exp_f32 v114, v114
    v_exp_f32 v115, v115
    s_waitcnt vmcnt(8)
    s_cmp_lg_u32 s82, 0
    s_cbranch_scc1 L_wt_17
    buffer_store_dwordx2 v[16:17], v10, s[28:31], s44 offen
L_wt_17_r:
    s_add_u32 s44, s44, 0x2000
    v_exp_f32 v116, v116
    buffer_load_dwordx4 v[180:183], v2, s[28:31], s50 offen offset:1024 sc1
    v_exp_f32 v117, v117
    v_exp_f32 v118, v118
    v_exp_f32 v119, v119
    v_pk_add_f32 v[112:113], v[112:113], 1.0 op_sel_hi:[1,0]
    v_pk_add_f32 v[114:115], v[114:115], 1.0 op_sel_hi:[1,0]
    v_pk_add_f32 v[116:117], v[116:117], 1.0 op_sel_hi:[1,0]
    s_add_u32 s49, s47, 0x4000
    buffer_load_dwordx4 v[184:187], v2, s[28:31], s49 offen offset:0 sc1
    v_pk_add_f32 v[118:119], v[118:119], 1.0 op_sel_hi:[1,0]
    v_rcp_f32 v112, v112
    v_rcp_f32 v113, v113
    v_rcp_f32 v114, v114
    v_rcp_f32 v115, v115
    v_rcp_f32 v116, v116
    s_add_u32 s50, s48, 0x4000
    buffer_load_dwordx4 v[188:191], v2, s[28:31], s50 offen offset:0 sc1
    v_rcp_f32 v117, v117
    v_rcp_f32 v118, v118
    v_rcp_f32 v119, v119
    v_pk_mul_f32 v[112:113], v[112:113], v[80:81]
    v_pk_mul_f32 v[114:115], v[114:115], v[82:83]
    v_pk_mul_f32 v[116:117], v[116:117], v[84:85]
    buffer_load_dwordx4 v[192:195], v2, s[28:31], s49 offen offset:1024 sc1
    v_pk_mul_f32 v[118:119], v[118:119], v[86:87]
    v_cvt_pk_bf16_f32 v108, v112, v113
    v_cvt_pk_bf16_f32 v109, v114, v115
    v_cvt_pk_bf16_f32 v110, v116, v117
    v_cvt_pk_bf16_f32 v111, v118, v119
    s_cmp_lg_u32 s82, 0
    s_cbranch_scc1 L_wt_18
    buffer_store_dwordx4 v[108:111], v2, s[28:31], s3 offen offset:3072
L_wt_18_r:
    buffer_load_dwordx4 v[196:199], v2, s[28:31], s50 offen offset:1024 sc1
    s_add_u32 s43, s43, 0x2000
    s_mov_b64 exec, 0xf
    buffer_load_dwordx4 v[20:23], v2, s[28:31], s43 offen sc1
    s_mov_b64 exec, -1
    s_waitcnt vmcnt(15)
    v_mfma_f32_32x32x16_bf16 v[68:83], a[4:7], v[152:155], 0
    s_add_u32 s49, s47, 0x5000
    buffer_load_dwordx4 v[200:203], v2, s[28:31], s49 offen offset:0 sc1
    v_mfma_f32_32x32x16_bf16 v[36:51], a[0:3], v[152:155], 0
    s_xor_b32 s45, s66, 0
    s_mul_i32 s45, s45, 12288
    v_add_u32 v116, s45, v2
    s_waitcnt vmcnt(15)
    v_mfma_f32_32x32x16_bf16 v[84:99], a[4:7], v[156:159], 0
    s_add_u32 s50, s48, 0x5000
    buffer_load_dwordx4 v[204:207], v2, s[28:31], s50 offen offset:0 sc1
    v_mfma_f32_32x32x16_bf16 v[52:67], a[0:3], v[156:159], 0
    s_xor_b32 s45, s66, 1
    s_mul_i32 s45, s45, 12288
    v_add_u32 v117, s45, v2
    s_waitcnt vmcnt(15)
    v_mfma_f32_32x32x16_bf16 v[68:83], a[12:15], v[160:163], v[68:83]
    buffer_load_dwordx4 v[208:211], v2, s[28:31], s49 offen offset:1024 sc1
    v_mfma_f32_32x32x16_bf16 v[36:51], a[8:11], v[160:163], v[36:51]
    s_xor_b32 s45, s66, 2
    s_mul_i32 s45, s45, 12288
    v_add_u32 v118, s45, v2
    s_waitcnt vmcnt(15)
    v_mfma_f32_32x32x16_bf16 v[84:99], a[12:15], v[164:167], v[84:99]
    buffer_load_dwordx4 v[212:215], v2, s[28:31], s50 offen offset:1024 sc1
    v_mfma_f32_32x32x16_bf16 v[52:67], a[8:11], v[164:167], v[52:67]
    s_xor_b32 s45, s66, 3
    s_mul_i32 s45, s45, 12288
    v_add_u32 v119, s45, v2
    s_waitcnt vmcnt(15)
    v_mfma_f32_32x32x16_bf16 v[68:83], a[20:23], v[168:171], v[68:83]
    v_mfma_f32_32x32x16_bf16 v[36:51], a[16:19], v[168:171], v[36:51]
    v_lshlrev_b32 v100, 16, v28
    v_and_b32 v101, 0xffff0000, v28
    v_lshlrev_b32 v102, 16, v29
    s_waitcnt vmcnt(14)
    v_mfma_f32_32x32x16_bf16 v[84:99], a[20:23], v[172:175], v[84:99]
    v_mfma_f32_32x32x16_bf16 v[52:67], a[16:19], v[172:175], v[52:67]
    v_and_b32 v103, 0xffff0000, v29
    v_lshlrev_b32 v104, 16, v30
    v_and_b32 v105, 0xffff0000, v30
    s_waitcnt vmcnt(4)
    s_mov_b64 exec, 0xf
    v_cmp_ne_u64 vcc, s[58:59], v[20:21]
    v_cmp_ne_u64 s[60:61], s[58:59], v[22:23]
    s_mov_b64 exec, -1
    s_or_b32 s70, vcc_lo, s60
    s_cbranch_scc0 L_spin_f1_19_d
    s_mov_b32 s71, 0x40000
L_spin_f1_19_l:
    s_mov_b64 exec, 0xf
    buffer_load_dwordx4 v[20:23], v2, s[28:31], s43 offen sc1
    s_waitcnt vmcnt(0)
    v_cmp_ne_u64 vcc, s[58:59], v[20:21]
    v_cmp_ne_u64 s[60:61], s[58:59], v[22:23]
    s_mov_b64 exec, -1
    s_or_b32 s70, vcc_lo, s60
    s_cbranch_scc0 L_spin_f1_19_d
    s_sub_u32 s71, s71, 1
    s_cbranch_scc0 L_spin_f1_19_l
L_spin_f1_19_d:
    s_add_u32 s49, s47, 0x400000
    buffer_load_dwordx4 v[216:219], v2, s[28:31], s49 offen offset:0 sc1
    s_add_u32 s50, s48, 0x400000
    buffer_load_dwordx4 v[220:223], v2, s[28:31], s50 offen offset:0 sc1
    v_mfma_f32_32x32x16_bf16 v[68:83], a[28:31], v[176:179], v[68:83]
    buffer_load_dwordx4 v[224:227], v2, s[28:31], s49 offen offset:1024 sc1
    v_mfma_f32_32x32x16_bf16 v[36:51], a[24:27], v[176:179], v[36:51]
    v_lshlrev_b32 v106, 16, v31
    v_and_b32 v107, 0xffff0000, v31
    v_lshlrev_b32 v108, 16, v32
    v_mfma_f32_32x32x16_bf16 v[84:99], a[28:31], v[180:183], v[84:99]
    buffer_load_dwordx4 v[228:231], v2, s[28:31], s50 offen offset:1024 sc1
    v_mfma_f32_32x32x16_bf16 v[52:67], a[24:27], v[180:183], v[52:67]
    v_and_b32 v109, 0xffff0000, v32
    v_lshlrev_b32 v110, 16, v33
    v_and_b32 v111, 0xffff0000, v33
    v_mfma_f32_32x32x16_bf16 v[68:83], a[132:135], v[184:187], v[68:83]
    s_add_u32 s49, s47, 0x401000
    buffer_load_dwordx4 v[232:235], v2, s[28:31], s49 offen offset:0 sc1
    v_mfma_f32_32x32x16_bf16 v[36:51], a[128:131], v[184:187], v[36:51]
    v_lshlrev_b32 v112, 16, v34
    v_and_b32 v113, 0xffff0000, v34
    v_lshlrev_b32 v114, 16, v35
    v_mfma_f32_32x32x16_bf16 v[84:99], a[132:135], v[188:191], v[84:99]
    s_add_u32 s50, s48, 0x401000
    buffer_load_dwordx4 v[236:239], v2, s[28:31], s50 offen offset:0 sc1
    v_mfma_f32_32x32x16_bf16 v[52:67], a[128:131], v[188:191], v[52:67]
    v_and_b32 v115, 0xffff0000, v35
    s_lshl_b32 s45, s67, 5
    v_add_u32 v26, s45, v11
    s_cmp_lg_u32 s82, 0
    s_cbranch_scc1 L_wt_20
    buffer_store_dwordx2 v[16:17], v10, s[28:31], s44 offen
L_wt_20_r:
    s_add_u32 s44, s44, 0x2000
    v_mfma_f32_32x32x16_bf16 v[68:83], a[140:143], v[192:195], v[68:83]
    buffer_load_dwordx4 v[240:243], v2, s[28:31], s49 offen offset:1024 sc1
    v_mfma_f32_32x32x16_bf16 v[36:51], a[136:139], v[192:195], v[36:51]
    v_mul_u32_u24 v26, 144, v26
    s_lshl_b32 s45, s68, 6
    s_add_u32 s45, s45, 49152
    v_mfma_f32_32x32x16_bf16 v[84:99], a[140:143], v[196:199], v[84:99]
    buffer_load_dwordx4 v[244:247], v2, s[28:31], s50 offen offset:1024 sc1
    v_mfma_f32_32x32x16_bf16 v[52:67], a[136:139], v[196:199], v[52:67]
    v_lshl_add_u32 v27, v18, 3, s45
    v_add_u32 v26, v26, v27
    v_lshrrev_b32 v120, 3, v1
    s_waitcnt vmcnt(12)
    v_mfma_f32_32x32x16_bf16 v[68:83], a[148:151], v[200:203], v[68:83]
    s_add_u32 s49, s47, 0x404000
    buffer_load_dwordx4 v[152:155], v2, s[28:31], s49 offen offset:0 sc1
    v_mfma_f32_32x32x16_bf16 v[36:51], a[144:147], v[200:203], v[36:51]
    v_and_b32 v121, 7, v1
    v_lshlrev_b32 v121, 4, v121
    v_mul_u32_u24 v27, 144, v120
    s_waitcnt vmcnt(12)
    v_mfma_f32_32x32x16_bf16 v[84:99], a[148:151], v[204:207], v[84:99]
    s_add_u32 s50, s48, 0x404000
    buffer_load_dwordx4 v[156:159], v2, s[28:31], s50 offen offset:0 sc1
    v_mfma_f32_32x32x16_bf16 v[52:67], a[144:147], v[204:207], v[52:67]
    s_mul_i32 s45, s66, 2304
    s_add_u32 s45, s45, 49152
    v_add3_u32 v27, v27, v121, s45
    s_waitcnt vmcnt(12)
    v_mfma_f32_32x32x16_bf16 v[68:83], a[156:159], v[208:211], v[68:83]
    buffer_load_dwordx4 v[160:163], v2, s[28:31], s49 offen offset:1024 sc1
    v_mfma_f32_32x32x16_bf16 v[36:51], a[152:155], v[208:211], v[36:51]
    v_lshl_add_u32 v120, v120, 10, v121
    s_lshl_b32 s51, s64, 16
    s_lshl_b32 s46, s66, 14
    s_waitcnt vmcnt(12)
    v_mfma_f32_32x32x16_bf16 v[84:99], a[156:159], v[212:215], v[84:99]
    buffer_load_dwordx4 v[164:167], v2, s[28:31], s50 offen offset:1024 sc1
    v_mfma_f32_32x32x16_bf16 v[52:67], a[152:155], v[212:215], v[52:67]
    s_add_u32 s51, s51, s46
    s_lshl_b32 s46, s65, 7
    s_add_u32 s51, s51, s46
    s_waitcnt vmcnt(12)
    v_mfma_f32_32x32x16_bf16 v[68:83], a[36:39], v[216:219], v[68:83]
    s_add_u32 s49, s47, 0x405000
    buffer_load_dwordx4 v[168:171], v2, s[28:31], s49 offen offset:0 sc1
    v_mfma_f32_32x32x16_bf16 v[36:51], a[32:35], v[216:219], v[36:51]
    s_add_u32 s56, s51, 8192
    v_mov_b32 v122, v25
    s_waitcnt vmcnt(12)
    v_mfma_f32_32x32x16_bf16 v[84:99], a[36:39], v[220:223], v[84:99]
    s_add_u32 s50, s48, 0x405000
    buffer_load_dwordx4 v[172:175], v2, s[28:31], s50 offen offset:0 sc1
    v_mfma_f32_32x32x16_bf16 v[52:67], a[32:35], v[220:223], v[52:67]
    s_waitcnt vmcnt(12)
    v_mfma_f32_32x32x16_bf16 v[68:83], a[44:47], v[224:227], v[68:83]
    buffer_load_dwordx4 v[176:179], v2, s[28:31], s49 offen offset:1024 sc1
    s_add_u32 s43, s43, 0x2000
    s_mov_b64 exec, 0xf
    buffer_load_dwordx4 v[20:23], v2, s[28:31], s43 offen sc1
    s_mov_b64 exec, -1
    v_mfma_f32_32x32x16_bf16 v[36:51], a[40:43], v[224:227], v[36:51]
    s_waitcnt vmcnt(13)
    v_mfma_f32_32x32x16_bf16 v[84:99], a[44:47], v[228:231], v[84:99]
    buffer_load_dwordx4 v[180:183], v2, s[28:31], s50 offen offset:1024 sc1
    v_mfma_f32_32x32x16_bf16 v[52:67], a[40:43], v[228:231], v[52:67]
    s_waitcnt vmcnt(13)
    v_mfma_f32_32x32x16_bf16 v[68:83], a[52:55], v[232:235], v[68:83]
    s_add_u32 s49, s47, 0x400000
    buffer_load_dwordx4 v[184:187], v2, s[28:31], s49 offen offset:2048 sc1
    v_mfma_f32_32x32x16_bf16 v[36:51], a[48:51], v[232:235], v[36:51]
    s_waitcnt vmcnt(13)
    v_mfma_f32_32x32x16_bf16 v[84:99], a[52:55], v[236:239], v[84:99]
    s_add_u32 s50, s48, 0x400000
    buffer_load_dwordx4 v[188:191], v2, s[28:31], s50 offen offset:2048 sc1
    v_mfma_f32_32x32x16_bf16 v[52:67], a[48:51], v[236:239], v[52:67]
    s_waitcnt vmcnt(12)
    v_mfma_f32_32x32x16_bf16 v[68:83], a[60:63], v[240:243], v[68:83]
    s_add_u32 s49, s47, 0x401000
    buffer_load_dwordx4 v[192:195], v2, s[28:31], s49 offen offset:2048 sc1
    v_mfma_f32_32x32x16_bf16 v[36:51], a[56:59], v[240:243], v[36:51]
    s_waitcnt vmcnt(12)
    v_mfma_f32_32x32x16_bf16 v[84:99], a[60:63], v[244:247], v[84:99]
    s_add_u32 s50, s48, 0x401000
    buffer_load_dwordx4 v[196:199], v2, s[28:31], s50 offen offset:2048 sc1
    v_mfma_f32_32x32x16_bf16 v[52:67], a[56:59], v[244:247], v[52:67]
    s_waitcnt vmcnt(12)
    v_mfma_f32_32x32x16_bf16 v[68:83], a[164:167], v[152:155], v[68:83]
    s_add_u32 s49, s47, 0x404000
    buffer_load_dwordx4 v[200:203], v2, s[28:31], s49 offen offset:2048 sc1
    v_mfma_f32_32x32x16_bf16 v[36:51], a[160:163], v[152:155], v[36:51]
    s_waitcnt vmcnt(12)
    v_mfma_f32_32x32x16_bf16 v[84:99], a[164:167], v[156:159], v[84:99]
    s_add_u32 s50, s48, 0x404000
    buffer_load_dwordx4 v[204:207], v2, s[28:31], s50 offen offset:2048 sc1
    v_mfma_f32_32x32x16_bf16 v[52:67], a[160:163], v[156:159], v[52:67]
    s_waitcnt vmcnt(12)
    v_mfma_f32_32x32x16_bf16 v[68:83], a[172:175], v[160:163], v[68:83]
    s_add_u32 s49, s47, 0x405000
    buffer_load_dwordx4 v[208:211], v2, s[28:31], s49 offen offset:2048 sc1
    v_mfma_f32_32x32x16_bf16 v[36:51], a[168:171], v[160:163], v[36:51]
    s_waitcnt vmcnt(12)
    v_mfma_f32_32x32x16_bf16 v[84:99], a[172:175], v[164:167], v[84:99]
    s_add_u32 s50, s48, 0x405000
    buffer_load_dwordx4 v[212:215], v2, s[28:31], s50 offen offset:2048 sc1
    v_mfma_f32_32x32x16_bf16 v[52:67], a[168:171], v[164:167], v[52:67]
    s_waitcnt vmcnt(12)
    v_mfma_f32_32x32x16_bf16 v[68:83], a[180:183], v[168:171], v[68:83]
    v_mfma_f32_32x32x16_bf16 v[36:51], a[176:179], v[168:171], v[36:51]
    s_waitcnt vmcnt(11)
    v_mfma_f32_32x32x16_bf16 v[84:99], a[180:183], v[172:175], v[84:99]
    v_mfma_f32_32x32x16_bf16 v[52:67], a[176:179], v[172:175], v[52:67]
    s_waitcnt vmcnt(10)
    v_mfma_f32_32x32x16_bf16 v[68:83], a[188:191], v[176:179], v[68:83]
    v_mfma_f32_32x32x16_bf16 v[36:51], a[184:187], v[176:179], v[36:51]
    s_waitcnt vmcnt(8)
    v_mfma_f32_32x32x16_bf16 v[84:99], a[188:191], v[180:183], v[84:99]
    v_mfma_f32_32x32x16_bf16 v[52:67], a[184:187], v[180:183], v[52:67]
    s_mov_b64 exec, 0xf
    v_cmp_ne_u64 vcc, s[58:59], v[20:21]
    v_cmp_ne_u64 s[60:61], s[58:59], v[22:23]
    s_mov_b64 exec, -1
    s_or_b32 s70, vcc_lo, s60
    s_cbranch_scc0 L_spin_f2_21_d
    s_mov_b32 s71, 0x40000
L_spin_f2_21_l:
    s_mov_b64 exec, 0xf
    buffer_load_dwordx4 v[20:23], v2, s[28:31], s43 offen sc1
    s_waitcnt vmcnt(0)
    v_cmp_ne_u64 vcc, s[58:59], v[20:21]
    v_cmp_ne_u64 s[60:61], s[58:59], v[22:23]
    s_mov_b64 exec, -1
    s_or_b32 s70, vcc_lo, s60
    s_cbranch_scc0 L_spin_f2_21_d
    s_sub_u32 s71, s71, 1
    s_cbranch_scc0 L_spin_f2_21_l
L_spin_f2_21_d:
    s_add_u32 s50, s48, 0x0
    buffer_load_dwordx4 v[216:219], v2, s[28:31], s50 offen offset:2048 sc1
    buffer_load_dwordx4 v[220:223], v2, s[28:31], s50 offen offset:3072 sc1
    s_waitcnt vmcnt(9)
    v_mfma_f32_32x32x16_bf16 v[68:83], a[100:103], v[184:187], v[68:83]
    s_add_u32 s50, s48, 0x1000
    buffer_load_dwordx4 v[224:227], v2, s[28:31], s50 offen offset:2048 sc1
    v_mfma_f32_32x32x16_bf16 v[36:51], a[96:99], v[184:187], v[36:51]
    s_waitcnt vmcnt(9)
    v_mfma_f32_32x32x16_bf16 v[84:99], a[100:103], v[188:191], v[84:99]
    buffer_load_dwordx4 v[228:231], v2, s[28:31], s50 offen offset:3072 sc1
    v_mfma_f32_32x32x16_bf16 v[52:67], a[96:99], v[188:191], v[52:67]
    s_waitcnt vmcnt(9)
    v_mfma_f32_32x32x16_bf16 v[68:83], a[108:111], v[192:195], v[68:83]
    s_add_u32 s50, s48, 0x4000
    buffer_load_dwordx4 v[232:235], v2, s[28:31], s50 offen offset:2048 sc1
    v_mfma_f32_32x32x16_bf16 v[36:51], a[104:107], v[192:195], v[36:51]
    s_waitcnt vmcnt(9)
    v_mfma_f32_32x32x16_bf16 v[84:99], a[108:111], v[196:199], v[84:99]
    buffer_load_dwordx4 v[236:239], v2, s[28:31], s50 offen offset:3072 sc1
    v_mfma_f32_32x32x16_bf16 v[52:67], a[104:107], v[196:199], v[52:67]
    s_waitcnt vmcnt(9)
    v_mfma_f32_32x32x16_bf16 v[68:83], a[116:119], v[200:203], v[68:83]
    s_add_u32 s50, s48, 0x5000
    buffer_load_dwordx4 v[240:243], v2, s[28:31], s50 offen offset:2048 sc1
    v_mfma_f32_32x32x16_bf16 v[36:51], a[112:115], v[200:203], v[36:51]
    s_waitcnt vmcnt(9)
    v_mfma_f32_32x32x16_bf16 v[84:99], a[116:119], v[204:207], v[84:99]
    buffer_load_dwordx4 v[244:247], v2, s[28:31], s50 offen offset:3072 sc1
    v_mfma_f32_32x32x16_bf16 v[52:67], a[112:115], v[204:207], v[52:67]
    s_barrier
    s_waitcnt vmcnt(9)
    v_mfma_f32_32x32x16_bf16 v[68:83], a[124:127], v[208:211], v[68:83]
    s_add_u32 s49, s47, 0x0
    buffer_load_dwordx4 v[152:155], v2, s[28:31], s49 offen offset:2048 sc1
    v_mfma_f32_32x32x16_bf16 v[36:51], a[120:123], v[208:211], v[36:51]
    s_waitcnt vmcnt(9)
    v_mfma_f32_32x32x16_bf16 v[84:99], a[124:127], v[212:215], v[84:99]
    buffer_load_dwordx4 v[156:159], v2, s[28:31], s49 offen offset:3072 sc1
    v_mfma_f32_32x32x16_bf16 v[52:67], a[120:123], v[212:215], v[52:67]
    s_waitcnt vmcnt(9)
    v_mfma_f32_32x32x16_bf16 v[84:99], a[68:71], v[216:219], v[84:99]
    s_add_u32 s49, s47, 0x1000
    buffer_load_dwordx4 v[160:163], v2, s[28:31], s49 offen offset:2048 sc1
    v_mfma_f32_32x32x16_bf16 v[52:67], a[64:67], v[216:219], v[52:67]
    s_waitcnt vmcnt(9)
    v_mfma_f32_32x32x16_bf16 v[84:99], a[76:79], v[220:223], v[84:99]
    buffer_load_dwordx4 v[164:167], v2, s[28:31], s49 offen offset:3072 sc1
    v_mfma_f32_32x32x16_bf16 v[52:67], a[72:75], v[220:223], v[52:67]
    s_waitcnt vmcnt(9)
    v_mfma_f32_32x32x16_bf16 v[84:99], a[84:87], v[224:227], v[84:99]
    s_add_u32 s49, s47, 0x4000
    buffer_load_dwordx4 v[168:171], v2, s[28:31], s49 offen offset:2048 sc1
    v_mfma_f32_32x32x16_bf16 v[52:67], a[80:83], v[224:227], v[52:67]
    s_waitcnt vmcnt(9)
    v_mfma_f32_32x32x16_bf16 v[84:99], a[92:95], v[228:231], v[84:99]
    buffer_load_dwordx4 v[172:175], v2, s[28:31], s49 offen offset:3072 sc1
    v_mfma_f32_32x32x16_bf16 v[52:67], a[88:91], v[228:231], v[52:67]
    s_waitcnt vmcnt(9)
    v_mfma_f32_32x32x16_bf16 v[84:99], a[196:199], v[232:235], v[84:99]
    s_add_u32 s49, s47, 0x5000
    buffer_load_dwordx4 v[176:179], v2, s[28:31], s49 offen offset:2048 sc1
    v_mfma_f32_32x32x16_bf16 v[52:67], a[192:195], v[232:235], v[52:67]
    s_waitcnt vmcnt(9)
    v_mfma_f32_32x32x16_bf16 v[84:99], a[204:207], v[236:239], v[84:99]
    buffer_load_dwordx4 v[180:183], v2, s[28:31], s49 offen offset:3072 sc1
    v_mfma_f32_32x32x16_bf16 v[52:67], a[200:203], v[236:239], v[52:67]
    s_waitcnt vmcnt(9)
    v_mfma_f32_32x32x16_bf16 v[84:99], a[212:215], v[240:243], v[84:99]
    v_mfma_f32_32x32x16_bf16 v[52:67], a[208:211], v[240:243], v[52:67]
    s_waitcnt vmcnt(8)
    v_mfma_f32_32x32x16_bf16 v[84:99], a[220:223], v[244:247], v[84:99]
    v_mfma_f32_32x32x16_bf16 v[52:67], a[216:219], v[244:247], v[52:67]
    s_waitcnt vmcnt(7)
    v_mfma_f32_32x32x16_bf16 v[68:83], a[68:71], v[152:155], v[68:83]
    v_mfma_f32_32x32x16_bf16 v[36:51], a[64:67], v[152:155], v[36:51]
    s_waitcnt vmcnt(6)
    v_mfma_f32_32x32x16_bf16 v[68:83], a[76:79], v[156:159], v[68:83]
    s_nop 6
    ds_write_b128 v117, v[52:55] offset:0
    v_mfma_f32_32x32x16_bf16 v[36:51], a[72:75], v[156:159], v[36:51]
    ds_write_b128 v117, v[56:59] offset:1024
    s_waitcnt vmcnt(5)
    v_mfma_f32_32x32x16_bf16 v[68:83], a[84:87], v[160:163], v[68:83]
    ds_write_b128 v117, v[60:63] offset:2048
    v_mfma_f32_32x32x16_bf16 v[36:51], a[80:83], v[160:163], v[36:51]
    ds_write_b128 v117, v[64:67] offset:3072
    s_waitcnt vmcnt(4)
    v_mfma_f32_32x32x16_bf16 v[68:83], a[92:95], v[164:167], v[68:83]
    ds_write_b128 v119, v[84:87] offset:8192
    v_mfma_f32_32x32x16_bf16 v[36:51], a[88:91], v[164:167], v[36:51]
    ds_write_b128 v119, v[88:91] offset:9216
    s_waitcnt vmcnt(3)
    v_mfma_f32_32x32x16_bf16 v[68:83], a[196:199], v[168:171], v[68:83]
    ds_write_b128 v119, v[92:95] offset:10240
    v_mfma_f32_32x32x16_bf16 v[36:51], a[192:195], v[168:171], v[36:51]
    ds_write_b128 v119, v[96:99] offset:11264
    s_waitcnt vmcnt(2)
    v_mfma_f32_32x32x16_bf16 v[68:83], a[204:207], v[172:175], v[68:83]
    s_waitcnt vmcnt(1)
    v_mfma_f32_32x32x16_bf16 v[68:83], a[212:215], v[176:179], v[68:83]
    s_waitcnt vmcnt(0)
    v_mfma_f32_32x32x16_bf16 v[68:83], a[220:223], v[180:183], v[68:83]
    s_and_b32 s69, s2, 0xf8
    s_or_b32 s69, s69, s66
    s_cbranch_scc1 L_wb_22
    buffer_wbl2 sc1
L_wb_22:
    v_mfma_f32_32x32x16_bf16 v[36:51], a[200:203], v[172:175], v[36:51]
    v_mfma_f32_32x32x16_bf16 v[36:51], a[208:211], v[176:179], v[36:51]
    s_nop 6
    ds_write_b128 v118, v[68:71] offset:4096
    ds_write_b128 v118, v[72:75] offset:5120
    v_mfma_f32_32x32x16_bf16 v[36:51], a[216:219], v[180:183], v[36:51]
    ds_write_b128 v118, v[76:79] offset:6144
    ds_write_b128 v118, v[80:83] offset:7168
    s_waitcnt lgkmcnt(0)
    s_barrier
    ds_read_b128 v[124:127], v116 offset:0
    ds_read_b128 v[140:143], v116 offset:4096
    ds_read_b128 v[156:159], v116 offset:8192
    ds_read_b128 v[128:131], v116 offset:1024
    ds_read_b128 v[144:147], v116 offset:5120
    ds_read_b128 v[160:163], v116 offset:9216
    ds_read_b128 v[132:135], v116 offset:2048
    ds_read_b128 v[148:151], v116 offset:6144
    ds_read_b128 v[164:167], v116 offset:10240
    ds_read_b128 v[136:139], v116 offset:3072
    ds_read_b128 v[152:155], v116 offset:7168
    ds_read_b128 v[168:171], v116 offset:11264
    s_waitcnt lgkmcnt(11)
    v_pk_add_f32 v[36:37], v[36:37], v[124:125]
    s_waitcnt lgkmcnt(9)
    v_pk_add_f32 v[140:141], v[140:141], v[156:157]
    v_pk_add_f32 v[38:39], v[38:39], v[126:127]
    v_pk_add_f32 v[142:143], v[142:143], v[158:159]
    s_waitcnt lgkmcnt(8)
    v_pk_add_f32 v[40:41], v[40:41], v[128:129]
    s_waitcnt lgkmcnt(6)
    v_pk_add_f32 v[144:145], v[144:145], v[160:161]
    v_pk_add_f32 v[42:43], v[42:43], v[130:131]
    v_pk_add_f32 v[146:147], v[146:147], v[162:163]
    v_pk_add_f32 v[36:37], v[36:37], v[140:141]
    v_pk_add_f32 v[38:39], v[38:39], v[142:143]
    v_pk_add_f32 v[40:41], v[40:41], v[144:145]
    v_pk_add_f32 v[42:43], v[42:43], v[146:147]
    v_pk_fma_f32 v[36:37], v[36:37], v[122:123], v[100:101] op_sel_hi:[1,0,1]
    v_pk_fma_f32 v[38:39], v[38:39], v[122:123], v[102:103] op_sel_hi:[1,0,1]
    v_pk_fma_f32 v[40:41], v[40:41], v[122:123], v[104:105] op_sel_hi:[1,0,1]
    v_pk_fma_f32 v[42:43], v[42:43], v[122:123], v[106:107] op_sel_hi:[1,0,1]
    v_cvt_pk_bf16_f32 v52, v36, v37
    v_cvt_pk_bf16_f32 v53, v38, v39
    v_cvt_pk_bf16_f32 v54, v40, v41
    v_cvt_pk_bf16_f32 v55, v42, v43
    ds_write_b64 v26, v[52:53] offset:0
    ds_write_b64 v26, v[54:55] offset:16
    s_waitcnt lgkmcnt(7)
    v_pk_add_f32 v[44:45], v[44:45], v[132:133]
    s_waitcnt lgkmcnt(5)
    v_pk_add_f32 v[148:149], v[148:149], v[164:165]
    v_pk_add_f32 v[46:47], v[46:47], v[134:135]
    v_pk_add_f32 v[150:151], v[150:151], v[166:167]
    s_waitcnt lgkmcnt(4)
    v_pk_add_f32 v[48:49], v[48:49], v[136:137]
    s_waitcnt lgkmcnt(2)
    v_pk_add_f32 v[152:153], v[152:153], v[168:169]
    v_pk_add_f32 v[50:51], v[50:51], v[138:139]
    v_pk_add_f32 v[154:155], v[154:155], v[170:171]
    v_pk_add_f32 v[44:45], v[44:45], v[148:149]
    v_pk_add_f32 v[46:47], v[46:47], v[150:151]
    v_pk_add_f32 v[48:49], v[48:49], v[152:153]
    v_pk_add_f32 v[50:51], v[50:51], v[154:155]
    v_pk_fma_f32 v[44:45], v[44:45], v[122:123], v[108:109] op_sel_hi:[1,0,1]
    v_pk_fma_f32 v[46:47], v[46:47], v[122:123], v[110:111] op_sel_hi:[1,0,1]
    v_pk_fma_f32 v[48:49], v[48:49], v[122:123], v[112:113] op_sel_hi:[1,0,1]
    v_pk_fma_f32 v[50:51], v[50:51], v[122:123], v[114:115] op_sel_hi:[1,0,1]
    v_cvt_pk_bf16_f32 v56, v44, v45
    v_cvt_pk_bf16_f32 v57, v46, v47
    v_cvt_pk_bf16_f32 v58, v48, v49
    v_cvt_pk_bf16_f32 v59, v50, v51
    ds_write_b64 v26, v[56:57] offset:32
    ds_write_b64 v26, v[58:59] offset:48
    s_waitcnt lgkmcnt(0)
    s_barrier
    ds_read_b128 v[68:71], v27 offset:0
    ds_read_b128 v[72:75], v27 offset:1152
    s_waitcnt lgkmcnt(1)
    buffer_store_dwordx4 v[68:71], v120, s[24:27], s51 offen sc1
    s_waitcnt lgkmcnt(0)
    buffer_store_dwordx4 v[72:75], v120, s[24:27], s56 offen sc1
    s_waitcnt vmcnt(0)
L_end:
    s_endpgm
L_softmax_max:
    s_waitcnt lgkmcnt(0)
    s_lshl_b32 s70, s64, 1
    s_add_u32 s70, s70, s67
    s_min_u32 s70, s70, 8
    s_sub_u32 s70, 8, s70
    v_mov_b32 v20, 0xff61b1e6
    v_mov_b32 v21, 0
    s_mov_b32 s69, s70
L_fb1_0:
    s_cmp_eq_u32 s69, 8
    s_cselect_b32 s71, 0, 64
    s_cmp_eq_u32 s69, 0
    s_cselect_b32 s77, 0, -16
    s_lshl_b32 s77, s77, 2
    s_mul_i32 s78, s69, 8320
    v_add_u32 v4, s78, v56
    ds_read_b128 v[108:111], v4 offset:0
    v_add_u32 v5, 0, v54
    v_cmp_ge_i32 vcc, s71, v5
    v_cmp_lt_i32 s[60:61], s77, v5
    s_nop 1
    s_and_b64 vcc, vcc, s[60:61]
    v_mov_b32 v5, 0xf149f2ca
    s_nop 1
    v_cndmask_b32 v76, v5, v21, vcc
    v_add_u32 v5, 1, v54
    v_cmp_ge_i32 vcc, s71, v5
    v_cmp_lt_i32 s[60:61], s77, v5
    s_nop 1
    s_and_b64 vcc, vcc, s[60:61]
    v_mov_b32 v5, 0xf149f2ca
    s_nop 1
    v_cndmask_b32 v77, v5, v21, vcc
    v_add_u32 v5, 2, v54
    v_cmp_ge_i32 vcc, s71, v5
    v_cmp_lt_i32 s[60:61], s77, v5
    s_nop 1
    s_and_b64 vcc, vcc, s[60:61]
    v_mov_b32 v5, 0xf149f2ca
    s_nop 1
    v_cndmask_b32 v78, v5, v21, vcc
    v_add_u32 v5, 3, v54
    v_cmp_ge_i32 vcc, s71, v5
    v_cmp_lt_i32 s[60:61], s77, v5
    s_nop 1
    s_and_b64 vcc, vcc, s[60:61]
    v_mov_b32 v5, 0xf149f2ca
    s_nop 1
    v_cndmask_b32 v79, v5, v21, vcc
    v_add_u32 v5, 8, v54
    v_cmp_ge_i32 vcc, s71, v5
    v_cmp_lt_i32 s[60:61], s77, v5
    s_nop 1
    s_and_b64 vcc, vcc, s[60:61]
    v_mov_b32 v5, 0xf149f2ca
    s_nop 1
    v_cndmask_b32 v80, v5, v21, vcc
    v_add_u32 v5, 9, v54
    v_cmp_ge_i32 vcc, s71, v5
    v_cmp_lt_i32 s[60:61], s77, v5
    s_nop 1
    s_and_b64 vcc, vcc, s[60:61]
    v_mov_b32 v5, 0xf149f2ca
    s_nop 1
    v_cndmask_b32 v81, v5, v21, vcc
    v_add_u32 v5, 10, v54
    v_cmp_ge_i32 vcc, s71, v5
    v_cmp_lt_i32 s[60:61], s77, v5
    s_nop 1
    s_and_b64 vcc, vcc, s[60:61]
    v_mov_b32 v5, 0xf149f2ca
    s_nop 1
    v_cndmask_b32 v82, v5, v21, vcc
    v_add_u32 v5, 11, v54
    v_cmp_ge_i32 vcc, s71, v5
    v_cmp_lt_i32 s[60:61], s77, v5
    s_nop 1
    s_and_b64 vcc, vcc, s[60:61]
    v_mov_b32 v5, 0xf149f2ca
    s_nop 1
    v_cndmask_b32 v83, v5, v21, vcc
    v_add_u32 v5, 16, v54
    v_cmp_ge_i32 vcc, s71, v5
    v_cmp_lt_i32 s[60:61], s77, v5
    s_nop 1
    s_and_b64 vcc, vcc, s[60:61]
    v_mov_b32 v5, 0xf149f2ca
    s_nop 1
    v_cndmask_b32 v84, v5, v21, vcc
    v_add_u32 v5, 17, v54
    v_cmp_ge_i32 vcc, s71, v5
    v_cmp_lt_i32 s[60:61], s77, v5
    s_nop 1
    s_and_b64 vcc, vcc, s[60:61]
    v_mov_b32 v5, 0xf149f2ca
    s_nop 1
    v_cndmask_b32 v85, v5, v21, vcc
    v_add_u32 v5, 18, v54
    v_cmp_ge_i32 vcc, s71, v5
    v_cmp_lt_i32 s[60:61], s77, v5
    s_nop 1
    s_and_b64 vcc, vcc, s[60:61]
    v_mov_b32 v5, 0xf149f2ca
    s_nop 1
    v_cndmask_b32 v86, v5, v21, vcc
    v_add_u32 v5, 19, v54
    v_cmp_ge_i32 vcc, s71, v5
    v_cmp_lt_i32 s[60:61], s77, v5
    s_nop 1
    s_and_b64 vcc, vcc, s[60:61]
    v_mov_b32 v5, 0xf149f2ca
    s_nop 1
    v_cndmask_b32 v87, v5, v21, vcc
    v_add_u32 v5, 24, v54
    v_cmp_ge_i32 vcc, s71, v5
    v_cmp_lt_i32 s[60:61], s77, v5
    s_nop 1
    s_and_b64 vcc, vcc, s[60:61]
    v_mov_b32 v5, 0xf149f2ca
    s_nop 1
    v_cndmask_b32 v88, v5, v21, vcc
    v_add_u32 v5, 25, v54
    v_cmp_ge_i32 vcc, s71, v5
    v_cmp_lt_i32 s[60:61], s77, v5
    s_nop 1
    s_and_b64 vcc, vcc, s[60:61]
    v_mov_b32 v5, 0xf149f2ca
    s_nop 1
    v_cndmask_b32 v89, v5, v21, vcc
    v_add_u32 v5, 26, v54
    v_cmp_ge_i32 vcc, s71, v5
    v_cmp_lt_i32 s[60:61], s77, v5
    s_nop 1
    s_and_b64 vcc, vcc, s[60:61]
    v_mov_b32 v5, 0xf149f2ca
    s_nop 1
    v_cndmask_b32 v90, v5, v21, vcc
    v_add_u32 v5, 27, v54
    v_cmp_ge_i32 vcc, s71, v5
    v_cmp_lt_i32 s[60:61], s77, v5
    s_nop 1
    s_and_b64 vcc, vcc, s[60:61]
    v_mov_b32 v5, 0xf149f2ca
    s_nop 1
    v_cndmask_b32 v91, v5, v21, vcc
    s_waitcnt lgkmcnt(0)
    s_nop 1
    v_mfma_f32_32x32x16_bf16 v[60:75], v[108:111], v[36:39], v[76:91]
    s_nop 15
    v_max3_f32 v20, v60, v61, v20
    v_max3_f32 v20, v62, v63, v20
    v_max3_f32 v20, v64, v65, v20
    v_max3_f32 v20, v66, v67, v20
    v_max3_f32 v20, v68, v69, v20
    v_max3_f32 v20, v70, v71, v20
    v_max3_f32 v20, v72, v73, v20
    v_max3_f32 v20, v74, v75, v20
    s_add_u32 s69, s69, 1
    s_cmp_le_u32 s69, 8
    s_cbranch_scc1 L_fb1_0
    v_mov_b32 v21, v20
    s_nop 1
    v_permlane32_swap_b32 v20, v21
    v_max_f32 v20, v20, v21
    v_sub_f32 v21, 0, v20
    v_accvgpr_write_b32 a224, 0
    v_accvgpr_write_b32 a225, 0
    v_accvgpr_write_b32 a226, 0
    v_accvgpr_write_b32 a227, 0
    v_accvgpr_write_b32 a228, 0
    v_accvgpr_write_b32 a229, 0
    v_accvgpr_write_b32 a230, 0
    v_accvgpr_write_b32 a231, 0
    v_accvgpr_write_b32 a232, 0
    v_accvgpr_write_b32 a233, 0
    v_accvgpr_write_b32 a234, 0
    v_accvgpr_write_b32 a235, 0
    v_accvgpr_write_b32 a236, 0
    v_accvgpr_write_b32 a237, 0
    v_accvgpr_write_b32 a238, 0
    v_accvgpr_write_b32 a239, 0
    s_mov_b32 s69, s70
L_fb2_0:
    s_cmp_eq_u32 s69, 8
    s_cselect_b32 s71, 0, 64
    s_cmp_eq_u32 s69, 0
    s_cselect_b32 s77, 0, -16
    s_lshl_b32 s77, s77, 2
    s_mul_i32 s78, s69, 8320
    v_add_u32 v4, s78, v56
    ds_read_b128 v[108:111], v4 offset:0
    v_add_u32 v5, 0, v54
    v_cmp_ge_i32 vcc, s71, v5
    v_cmp_lt_i32 s[60:61], s77, v5
    s_nop 1
    s_and_b64 vcc, vcc, s[60:61]
    v_mov_b32 v5, 0xf149f2ca
    s_nop 1
    v_cndmask_b32 v76, v5, v21, vcc
    v_add_u32 v5, 1, v54
    v_cmp_ge_i32 vcc, s71, v5
    v_cmp_lt_i32 s[60:61], s77, v5
    s_nop 1
    s_and_b64 vcc, vcc, s[60:61]
    v_mov_b32 v5, 0xf149f2ca
    s_nop 1
    v_cndmask_b32 v77, v5, v21, vcc
    v_add_u32 v5, 2, v54
    v_cmp_ge_i32 vcc, s71, v5
    v_cmp_lt_i32 s[60:61], s77, v5
    s_nop 1
    s_and_b64 vcc, vcc, s[60:61]
    v_mov_b32 v5, 0xf149f2ca
    s_nop 1
    v_cndmask_b32 v78, v5, v21, vcc
    v_add_u32 v5, 3, v54
    v_cmp_ge_i32 vcc, s71, v5
    v_cmp_lt_i32 s[60:61], s77, v5
    s_nop 1
    s_and_b64 vcc, vcc, s[60:61]
    v_mov_b32 v5, 0xf149f2ca
    s_nop 1
    v_cndmask_b32 v79, v5, v21, vcc
    v_add_u32 v5, 8, v54
    v_cmp_ge_i32 vcc, s71, v5
    v_cmp_lt_i32 s[60:61], s77, v5
    s_nop 1
    s_and_b64 vcc, vcc, s[60:61]
    v_mov_b32 v5, 0xf149f2ca
    s_nop 1
    v_cndmask_b32 v80, v5, v21, vcc
    v_add_u32 v5, 9, v54
    v_cmp_ge_i32 vcc, s71, v5
    v_cmp_lt_i32 s[60:61], s77, v5
    s_nop 1
    s_and_b64 vcc, vcc, s[60:61]
    v_mov_b32 v5, 0xf149f2ca
    s_nop 1
    v_cndmask_b32 v81, v5, v21, vcc
    v_add_u32 v5, 10, v54
    v_cmp_ge_i32 vcc, s71, v5
    v_cmp_lt_i32 s[60:61], s77, v5
    s_nop 1
    s_and_b64 vcc, vcc, s[60:61]
    v_mov_b32 v5, 0xf149f2ca
    s_nop 1
    v_cndmask_b32 v82, v5, v21, vcc
    v_add_u32 v5, 11, v54
    v_cmp_ge_i32 vcc, s71, v5
    v_cmp_lt_i32 s[60:61], s77, v5
    s_nop 1
    s_and_b64 vcc, vcc, s[60:61]
    v_mov_b32 v5, 0xf149f2ca
    s_nop 1
    v_cndmask_b32 v83, v5, v21, vcc
    v_add_u32 v5, 16, v54
    v_cmp_ge_i32 vcc, s71, v5
    v_cmp_lt_i32 s[60:61], s77, v5
    s_nop 1
    s_and_b64 vcc, vcc, s[60:61]
    v_mov_b32 v5, 0xf149f2ca
    s_nop 1
    v_cndmask_b32 v84, v5, v21, vcc
    v_add_u32 v5, 17, v54
    v_cmp_ge_i32 vcc, s71, v5
    v_cmp_lt_i32 s[60:61], s77, v5
    s_nop 1
    s_and_b64 vcc, vcc, s[60:61]
    v_mov_b32 v5, 0xf149f2ca
    s_nop 1
    v_cndmask_b32 v85, v5, v21, vcc
    v_add_u32 v5, 18, v54
    v_cmp_ge_i32 vcc, s71, v5
    v_cmp_lt_i32 s[60:61], s77, v5
    s_nop 1
    s_and_b64 vcc, vcc, s[60:61]
    v_mov_b32 v5, 0xf149f2ca
    s_nop 1
    v_cndmask_b32 v86, v5, v21, vcc
    v_add_u32 v5, 19, v54
    v_cmp_ge_i32 vcc, s71, v5
    v_cmp_lt_i32 s[60:61], s77, v5
    s_nop 1
    s_and_b64 vcc, vcc, s[60:61]
    v_mov_b32 v5, 0xf149f2ca
    s_nop 1
    v_cndmask_b32 v87, v5, v21, vcc
    v_add_u32 v5, 24, v54
    v_cmp_ge_i32 vcc, s71, v5
    v_cmp_lt_i32 s[60:61], s77, v5
    s_nop 1
    s_and_b64 vcc, vcc, s[60:61]
    v_mov_b32 v5, 0xf149f2ca
    s_nop 1
    v_cndmask_b32 v88, v5, v21, vcc
    v_add_u32 v5, 25, v54
    v_cmp_ge_i32 vcc, s71, v5
    v_cmp_lt_i32 s[60:61], s77, v5
    s_nop 1
    s_and_b64 vcc, vcc, s[60:61]
    v_mov_b32 v5, 0xf149f2ca
    s_nop 1
    v_cndmask_b32 v89, v5, v21, vcc
    v_add_u32 v5, 26, v54
    v_cmp_ge_i32 vcc, s71, v5
    v_cmp_lt_i32 s[60:61], s77, v5
    s_nop 1
    s_and_b64 vcc, vcc, s[60:61]
    v_mov_b32 v5, 0xf149f2ca
    s_nop 1
    v_cndmask_b32 v90, v5, v21, vcc
    v_add_u32 v5, 27, v54
    v_cmp_ge_i32 vcc, s71, v5
    v_cmp_lt_i32 s[60:61], s77, v5
    s_nop 1
    s_and_b64 vcc, vcc, s[60:61]
    v_mov_b32 v5, 0xf149f2ca
    s_nop 1
    v_cndmask_b32 v91, v5, v21, vcc
    s_waitcnt lgkmcnt(0)
    s_nop 1
    v_mfma_f32_32x32x16_bf16 v[60:75], v[108:111], v[36:39], v[76:91]
    s_nop 15
    v_add_u32 v4, s78, v57
    ds_read_b128 v[92:95], v4 offset:2080
    ds_read_b128 v[96:99], v4 offset:3120
    v_exp_f32 v60, v60
    v_exp_f32 v61, v61
    v_exp_f32 v62, v62
    v_exp_f32 v63, v63
    v_exp_f32 v64, v64
    v_exp_f32 v65, v65
    v_exp_f32 v66, v66
    v_exp_f32 v67, v67
    v_exp_f32 v68, v68
    v_exp_f32 v69, v69
    v_exp_f32 v70, v70
    v_exp_f32 v71, v71
    v_exp_f32 v72, v72
    v_exp_f32 v73, v73
    v_exp_f32 v74, v74
    v_exp_f32 v75, v75
    s_nop 0
    v_cvt_pk_bf16_f32 v100, v60, v61
    v_cvt_pk_bf16_f32 v101, v62, v63
    v_cvt_pk_bf16_f32 v102, v64, v65
    v_cvt_pk_bf16_f32 v103, v66, v67
    v_cvt_pk_bf16_f32 v104, v68, v69
    v_cvt_pk_bf16_f32 v105, v70, v71
    v_cvt_pk_bf16_f32 v106, v72, v73
    v_cvt_pk_bf16_f32 v107, v74, v75
    s_waitcnt lgkmcnt(0)
    s_nop 1
    v_mfma_f32_32x32x16_bf16 a[224:239], v[92:95], v[100:103], a[224:239]
    v_mfma_f32_32x32x16_bf16 a[224:239], v[96:99], v[104:107], a[224:239]
    s_add_u32 s69, s69, 1
    s_cmp_le_u32 s69, 8
    s_cbranch_scc1 L_fb2_0
    s_nop 15
    v_mov_b32 v20, 0xff61b1e6
    v_mov_b32 v21, 0
    s_mov_b32 s69, s70
L_fb1_1:
    s_cmp_eq_u32 s69, 8
    s_cselect_b32 s71, 0, 64
    s_cmp_eq_u32 s69, 0
    s_cselect_b32 s77, 0, -16
    s_lshl_b32 s77, s77, 2
    s_mul_i32 s78, s69, 8320
    v_add_u32 v4, s78, v56
    ds_read_b128 v[108:111], v4 offset:1040
    v_add_u32 v5, 0, v54
    v_cmp_ge_i32 vcc, s71, v5
    v_cmp_lt_i32 s[60:61], s77, v5
    s_nop 1
    s_and_b64 vcc, vcc, s[60:61]
    v_mov_b32 v5, 0xf149f2ca
    s_nop 1
    v_cndmask_b32 v76, v5, v21, vcc
    v_add_u32 v5, 1, v54
    v_cmp_ge_i32 vcc, s71, v5
    v_cmp_lt_i32 s[60:61], s77, v5
    s_nop 1
    s_and_b64 vcc, vcc, s[60:61]
    v_mov_b32 v5, 0xf149f2ca
    s_nop 1
    v_cndmask_b32 v77, v5, v21, vcc
    v_add_u32 v5, 2, v54
    v_cmp_ge_i32 vcc, s71, v5
    v_cmp_lt_i32 s[60:61], s77, v5
    s_nop 1
    s_and_b64 vcc, vcc, s[60:61]
    v_mov_b32 v5, 0xf149f2ca
    s_nop 1
    v_cndmask_b32 v78, v5, v21, vcc
    v_add_u32 v5, 3, v54
    v_cmp_ge_i32 vcc, s71, v5
    v_cmp_lt_i32 s[60:61], s77, v5
    s_nop 1
    s_and_b64 vcc, vcc, s[60:61]
    v_mov_b32 v5, 0xf149f2ca
    s_nop 1
    v_cndmask_b32 v79, v5, v21, vcc
    v_add_u32 v5, 8, v54
    v_cmp_ge_i32 vcc, s71, v5
    v_cmp_lt_i32 s[60:61], s77, v5
    s_nop 1
    s_and_b64 vcc, vcc, s[60:61]
    v_mov_b32 v5, 0xf149f2ca
    s_nop 1
    v_cndmask_b32 v80, v5, v21, vcc
    v_add_u32 v5, 9, v54
    v_cmp_ge_i32 vcc, s71, v5
    v_cmp_lt_i32 s[60:61], s77, v5
    s_nop 1
    s_and_b64 vcc, vcc, s[60:61]
    v_mov_b32 v5, 0xf149f2ca
    s_nop 1
    v_cndmask_b32 v81, v5, v21, vcc
    v_add_u32 v5, 10, v54
    v_cmp_ge_i32 vcc, s71, v5
    v_cmp_lt_i32 s[60:61], s77, v5
    s_nop 1
    s_and_b64 vcc, vcc, s[60:61]
    v_mov_b32 v5, 0xf149f2ca
    s_nop 1
    v_cndmask_b32 v82, v5, v21, vcc
    v_add_u32 v5, 11, v54
    v_cmp_ge_i32 vcc, s71, v5
    v_cmp_lt_i32 s[60:61], s77, v5
    s_nop 1
    s_and_b64 vcc, vcc, s[60:61]
    v_mov_b32 v5, 0xf149f2ca
    s_nop 1
    v_cndmask_b32 v83, v5, v21, vcc
    v_add_u32 v5, 16, v54
    v_cmp_ge_i32 vcc, s71, v5
    v_cmp_lt_i32 s[60:61], s77, v5
    s_nop 1
    s_and_b64 vcc, vcc, s[60:61]
    v_mov_b32 v5, 0xf149f2ca
    s_nop 1
    v_cndmask_b32 v84, v5, v21, vcc
    v_add_u32 v5, 17, v54
    v_cmp_ge_i32 vcc, s71, v5
    v_cmp_lt_i32 s[60:61], s77, v5
    s_nop 1
    s_and_b64 vcc, vcc, s[60:61]
    v_mov_b32 v5, 0xf149f2ca
    s_nop 1
    v_cndmask_b32 v85, v5, v21, vcc
    v_add_u32 v5, 18, v54
    v_cmp_ge_i32 vcc, s71, v5
    v_cmp_lt_i32 s[60:61], s77, v5
    s_nop 1
    s_and_b64 vcc, vcc, s[60:61]
    v_mov_b32 v5, 0xf149f2ca
    s_nop 1
    v_cndmask_b32 v86, v5, v21, vcc
    v_add_u32 v5, 19, v54
    v_cmp_ge_i32 vcc, s71, v5
    v_cmp_lt_i32 s[60:61], s77, v5
    s_nop 1
    s_and_b64 vcc, vcc, s[60:61]
    v_mov_b32 v5, 0xf149f2ca
    s_nop 1
    v_cndmask_b32 v87, v5, v21, vcc
    v_add_u32 v5, 24, v54
    v_cmp_ge_i32 vcc, s71, v5
    v_cmp_lt_i32 s[60:61], s77, v5
    s_nop 1
    s_and_b64 vcc, vcc, s[60:61]
    v_mov_b32 v5, 0xf149f2ca
    s_nop 1
    v_cndmask_b32 v88, v5, v21, vcc
    v_add_u32 v5, 25, v54
    v_cmp_ge_i32 vcc, s71, v5
    v_cmp_lt_i32 s[60:61], s77, v5
    s_nop 1
    s_and_b64 vcc, vcc, s[60:61]
    v_mov_b32 v5, 0xf149f2ca
    s_nop 1
    v_cndmask_b32 v89, v5, v21, vcc
    v_add_u32 v5, 26, v54
    v_cmp_ge_i32 vcc, s71, v5
    v_cmp_lt_i32 s[60:61], s77, v5
    s_nop 1
    s_and_b64 vcc, vcc, s[60:61]
    v_mov_b32 v5, 0xf149f2ca
    s_nop 1
    v_cndmask_b32 v90, v5, v21, vcc
    v_add_u32 v5, 27, v54
    v_cmp_ge_i32 vcc, s71, v5
    v_cmp_lt_i32 s[60:61], s77, v5
    s_nop 1
    s_and_b64 vcc, vcc, s[60:61]
    v_mov_b32 v5, 0xf149f2ca
    s_nop 1
    v_cndmask_b32 v91, v5, v21, vcc
    s_waitcnt lgkmcnt(0)
    s_nop 1
    v_mfma_f32_32x32x16_bf16 v[60:75], v[108:111], v[40:43], v[76:91]
    s_nop 15
    v_max3_f32 v20, v60, v61, v20
    v_max3_f32 v20, v62, v63, v20
    v_max3_f32 v20, v64, v65, v20
    v_max3_f32 v20, v66, v67, v20
    v_max3_f32 v20, v68, v69, v20
    v_max3_f32 v20, v70, v71, v20
    v_max3_f32 v20, v72, v73, v20
    v_max3_f32 v20, v74, v75, v20
    s_add_u32 s69, s69, 1
    s_cmp_le_u32 s69, 8
    s_cbranch_scc1 L_fb1_1
    v_mov_b32 v21, v20
    s_nop 1
    v_permlane32_swap_b32 v20, v21
    v_max_f32 v20, v20, v21
    v_sub_f32 v21, 0, v20
    v_accvgpr_write_b32 a240, 0
    v_accvgpr_write_b32 a241, 0
    v_accvgpr_write_b32 a242, 0
    v_accvgpr_write_b32 a243, 0
    v_accvgpr_write_b32 a244, 0
    v_accvgpr_write_b32 a245, 0
    v_accvgpr_write_b32 a246, 0
    v_accvgpr_write_b32 a247, 0
    v_accvgpr_write_b32 a248, 0
    v_accvgpr_write_b32 a249, 0
    v_accvgpr_write_b32 a250, 0
    v_accvgpr_write_b32 a251, 0
    v_accvgpr_write_b32 a252, 0
    v_accvgpr_write_b32 a253, 0
    v_accvgpr_write_b32 a254, 0
    v_accvgpr_write_b32 a255, 0
    s_mov_b32 s69, s70
L_fb2_1:
    s_cmp_eq_u32 s69, 8
    s_cselect_b32 s71, 0, 64
    s_cmp_eq_u32 s69, 0
    s_cselect_b32 s77, 0, -16
    s_lshl_b32 s77, s77, 2
    s_mul_i32 s78, s69, 8320
    v_add_u32 v4, s78, v56
    ds_read_b128 v[108:111], v4 offset:1040
    v_add_u32 v5, 0, v54
    v_cmp_ge_i32 vcc, s71, v5
    v_cmp_lt_i32 s[60:61], s77, v5
    s_nop 1
    s_and_b64 vcc, vcc, s[60:61]
    v_mov_b32 v5, 0xf149f2ca
    s_nop 1
    v_cndmask_b32 v76, v5, v21, vcc
    v_add_u32 v5, 1, v54
    v_cmp_ge_i32 vcc, s71, v5
    v_cmp_lt_i32 s[60:61], s77, v5
    s_nop 1
    s_and_b64 vcc, vcc, s[60:61]
    v_mov_b32 v5, 0xf149f2ca
    s_nop 1
    v_cndmask_b32 v77, v5, v21, vcc
    v_add_u32 v5, 2, v54
    v_cmp_ge_i32 vcc, s71, v5
    v_cmp_lt_i32 s[60:61], s77, v5
    s_nop 1
    s_and_b64 vcc, vcc, s[60:61]
    v_mov_b32 v5, 0xf149f2ca
    s_nop 1
    v_cndmask_b32 v78, v5, v21, vcc
    v_add_u32 v5, 3, v54
    v_cmp_ge_i32 vcc, s71, v5
    v_cmp_lt_i32 s[60:61], s77, v5
    s_nop 1
    s_and_b64 vcc, vcc, s[60:61]
    v_mov_b32 v5, 0xf149f2ca
    s_nop 1
    v_cndmask_b32 v79, v5, v21, vcc
    v_add_u32 v5, 8, v54
    v_cmp_ge_i32 vcc, s71, v5
    v_cmp_lt_i32 s[60:61], s77, v5
    s_nop 1
    s_and_b64 vcc, vcc, s[60:61]
    v_mov_b32 v5, 0xf149f2ca
    s_nop 1
    v_cndmask_b32 v80, v5, v21, vcc
    v_add_u32 v5, 9, v54
    v_cmp_ge_i32 vcc, s71, v5
    v_cmp_lt_i32 s[60:61], s77, v5
    s_nop 1
    s_and_b64 vcc, vcc, s[60:61]
    v_mov_b32 v5, 0xf149f2ca
    s_nop 1
    v_cndmask_b32 v81, v5, v21, vcc
    v_add_u32 v5, 10, v54
    v_cmp_ge_i32 vcc, s71, v5
    v_cmp_lt_i32 s[60:61], s77, v5
    s_nop 1
    s_and_b64 vcc, vcc, s[60:61]
    v_mov_b32 v5, 0xf149f2ca
    s_nop 1
    v_cndmask_b32 v82, v5, v21, vcc
    v_add_u32 v5, 11, v54
    v_cmp_ge_i32 vcc, s71, v5
    v_cmp_lt_i32 s[60:61], s77, v5
    s_nop 1
    s_and_b64 vcc, vcc, s[60:61]
    v_mov_b32 v5, 0xf149f2ca
    s_nop 1
    v_cndmask_b32 v83, v5, v21, vcc
    v_add_u32 v5, 16, v54
    v_cmp_ge_i32 vcc, s71, v5
    v_cmp_lt_i32 s[60:61], s77, v5
    s_nop 1
    s_and_b64 vcc, vcc, s[60:61]
    v_mov_b32 v5, 0xf149f2ca
    s_nop 1
    v_cndmask_b32 v84, v5, v21, vcc
    v_add_u32 v5, 17, v54
    v_cmp_ge_i32 vcc, s71, v5
    v_cmp_lt_i32 s[60:61], s77, v5
    s_nop 1
    s_and_b64 vcc, vcc, s[60:61]
    v_mov_b32 v5, 0xf149f2ca
    s_nop 1
    v_cndmask_b32 v85, v5, v21, vcc
    v_add_u32 v5, 18, v54
    v_cmp_ge_i32 vcc, s71, v5
    v_cmp_lt_i32 s[60:61], s77, v5
    s_nop 1
    s_and_b64 vcc, vcc, s[60:61]
    v_mov_b32 v5, 0xf149f2ca
    s_nop 1
    v_cndmask_b32 v86, v5, v21, vcc
    v_add_u32 v5, 19, v54
    v_cmp_ge_i32 vcc, s71, v5
    v_cmp_lt_i32 s[60:61], s77, v5
    s_nop 1
    s_and_b64 vcc, vcc, s[60:61]
    v_mov_b32 v5, 0xf149f2ca
    s_nop 1
    v_cndmask_b32 v87, v5, v21, vcc
    v_add_u32 v5, 24, v54
    v_cmp_ge_i32 vcc, s71, v5
    v_cmp_lt_i32 s[60:61], s77, v5
    s_nop 1
    s_and_b64 vcc, vcc, s[60:61]
    v_mov_b32 v5, 0xf149f2ca
    s_nop 1
    v_cndmask_b32 v88, v5, v21, vcc
    v_add_u32 v5, 25, v54
    v_cmp_ge_i32 vcc, s71, v5
    v_cmp_lt_i32 s[60:61], s77, v5
    s_nop 1
    s_and_b64 vcc, vcc, s[60:61]
    v_mov_b32 v5, 0xf149f2ca
    s_nop 1
    v_cndmask_b32 v89, v5, v21, vcc
    v_add_u32 v5, 26, v54
    v_cmp_ge_i32 vcc, s71, v5
    v_cmp_lt_i32 s[60:61], s77, v5
    s_nop 1
    s_and_b64 vcc, vcc, s[60:61]
    v_mov_b32 v5, 0xf149f2ca
    s_nop 1
    v_cndmask_b32 v90, v5, v21, vcc
    v_add_u32 v5, 27, v54
    v_cmp_ge_i32 vcc, s71, v5
    v_cmp_lt_i32 s[60:61], s77, v5
    s_nop 1
    s_and_b64 vcc, vcc, s[60:61]
    v_mov_b32 v5, 0xf149f2ca
    s_nop 1
    v_cndmask_b32 v91, v5, v21, vcc
    s_waitcnt lgkmcnt(0)
    s_nop 1
    v_mfma_f32_32x32x16_bf16 v[60:75], v[108:111], v[40:43], v[76:91]
    s_nop 15
    v_add_u32 v4, s78, v58
    ds_read_b128 v[92:95], v4 offset:2080
    ds_read_b128 v[96:99], v4 offset:3120
    v_exp_f32 v60, v60
    v_exp_f32 v61, v61
    v_exp_f32 v62, v62
    v_exp_f32 v63, v63
    v_exp_f32 v64, v64
    v_exp_f32 v65, v65
    v_exp_f32 v66, v66
    v_exp_f32 v67, v67
    v_exp_f32 v68, v68
    v_exp_f32 v69, v69
    v_exp_f32 v70, v70
    v_exp_f32 v71, v71
    v_exp_f32 v72, v72
    v_exp_f32 v73, v73
    v_exp_f32 v74, v74
    v_exp_f32 v75, v75
    s_nop 0
    v_cvt_pk_bf16_f32 v100, v60, v61
    v_cvt_pk_bf16_f32 v101, v62, v63
    v_cvt_pk_bf16_f32 v102, v64, v65
    v_cvt_pk_bf16_f32 v103, v66, v67
    v_cvt_pk_bf16_f32 v104, v68, v69
    v_cvt_pk_bf16_f32 v105, v70, v71
    v_cvt_pk_bf16_f32 v106, v72, v73
    v_cvt_pk_bf16_f32 v107, v74, v75
    s_waitcnt lgkmcnt(0)
    s_nop 1
    v_mfma_f32_32x32x16_bf16 a[240:255], v[92:95], v[100:103], a[240:255]
    v_mfma_f32_32x32x16_bf16 a[240:255], v[96:99], v[104:107], a[240:255]
    s_add_u32 s69, s69, 1
    s_cmp_le_u32 s69, 8
    s_cbranch_scc1 L_fb2_1
    s_nop 15
    v_accvgpr_read_b32 v44, a232
    v_accvgpr_read_b32 v45, a240
    s_nop 1
    s_branch L_softmax_join
L_nonce_spin_3:
    buffer_load_dwordx2 v[16:17], v10, s[32:35], 0 offen sc1
    s_waitcnt vmcnt(0)
    v_readfirstlane_b32 s58, v16
    v_readfirstlane_b32 s59, v17
    s_sub_u32 s71, s71, 1
    s_cbranch_scc1 L_nonce_ok_2
    s_cmp_eq_u32 s58, 0
    s_cbranch_scc1 L_nonce_spin_3
    s_branch L_nonce_ok_2
L_wt_5:
    buffer_store_dwordx4 v[100:103], v2, s[28:31], s3 offen offset:0 sc1
    s_branch L_wt_5_r
L_wt_6:
    buffer_store_dwordx4 v[104:107], v2, s[28:31], s3 offen offset:1024 sc1
    s_branch L_wt_6_r
L_wt_7:
    buffer_store_dwordx2 v[16:17], v10, s[28:31], s51 offen sc1
    s_branch L_wt_7_r
L_wt_9:
    buffer_store_dwordx4 v[152:155], v2, s[28:31], s3 offen offset:2048 sc1
    s_branch L_wt_9_r
L_wt_10:
    buffer_store_dwordx4 v[156:159], v2, s[28:31], s3 offen offset:3072 sc1
    s_branch L_wt_10_r
L_wt_11:
    buffer_store_dword v5, v7, s[28:31], s43 offen sc1
    s_branch L_wt_11_r
L_wt_12:
    buffer_store_dwordx2 v[16:17], v10, s[28:31], s77 offen sc1
    s_branch L_wt_12_r
L_wt_14:
    buffer_store_dwordx2 v[16:17], v10, s[28:31], s44 offen sc1
    s_branch L_wt_14_r
L_wt_16:
    buffer_store_dwordx4 v[104:107], v2, s[28:31], s3 offen offset:2048 sc1
    s_branch L_wt_16_r
L_wt_17:
    buffer_store_dwordx2 v[16:17], v10, s[28:31], s44 offen sc1
    s_branch L_wt_17_r
L_wt_18:
    buffer_store_dwordx4 v[108:111], v2, s[28:31], s3 offen offset:3072 sc1
    s_branch L_wt_18_r
L_wt_20:
    buffer_store_dwordx2 v[16:17], v10, s[28:31], s44 offen sc1
    s_branch L_wt_20_r
L_code_end:
.section .rodata,"a"
.p2align 6
.amdhsa_kernel sequential_preLN__sliding_block__dense_activation_silu__prompt_kernel
  .amdhsa_next_free_vgpr 512
  .amdhsa_next_free_sgpr 102
  .amdhsa_accum_offset 256
  .amdhsa_group_segment_fixed_size 0
  .amdhsa_kernarg_size 72
  .amdhsa_user_sgpr_count 2
  .amdhsa_user_sgpr_kernarg_segment_ptr 1
  .amdhsa_system_sgpr_workgroup_id_x 1
  .amdhsa_float_denorm_mode_32 3
.end_amdhsa_kernel
```
